```python
import torch

def _softmax(x, axis=-1):
    return torch.softmax(x, dim=axis)
def _gelu(x):
    return torch.nn.functional.gelu(x, approximate="tanh")
def _silu(x):
    return torch.nn.functional.silu(x)
def _sigmoid(x):
    return torch.sigmoid(x)
def _layernorm(x, axis=-1, eps=1e-5):
    m = x.mean(dim=axis, keepdim=True)
    v = x.var(dim=axis, keepdim=True, unbiased=False)
    return (x - m) / torch.sqrt(v + eps)
def _scatter_add(tgt, idx, src, axis=0):
    return tgt.clone().index_add_(axis, idx, src)
def _segment_sum(src, seg, n):
    out = torch.zeros((n,) + src.shape[1:], dtype=src.dtype)
    return out.index_add_(0, seg, src)
def _pad(x, pw):
    flat = tuple(v for pair in reversed(pw) for v in pair)
    return torch.nn.functional.pad(x, flat)

kernel_name = 'sequential_preLN__sliding_local_dilated__mixer_token_mlp__prompt'

def setup_inputs():

    _w = (lambda a: (lambda t: t.to(torch.bfloat16) if t.is_floating_point() else t)(torch.as_tensor(a)))
    def _A_setup():
        B, S, D = 1, 2048, 512
        return {
            "x": _w((lambda *s: torch.randn(*s, dtype=torch.bfloat16) * 0.05)(B, S, D)),
            "wqkv": _w((lambda *s: torch.randn(*s, dtype=torch.bfloat16) * 0.05)(D, 3 * D)),
            "wo": _w((lambda *s: torch.randn(*s, dtype=torch.bfloat16) * 0.05)(D, D)),
        }
    _A_in = _A_setup()

    def _B_setup():
        B, S, D, F = 1, 2048, 512, 1792
        return {
            "x": _w((lambda *s: torch.randn(*s, dtype=torch.bfloat16) * 0.05)(B, S, D)),
            "w1": _w((lambda *s: torch.randn(*s, dtype=torch.bfloat16) * 1.6)(S, F) * (S ** -0.5)),
            "b1": _w((lambda *s: torch.randn(*s, dtype=torch.bfloat16) * 12.8)(F) * 0.02),
            "w2": _w((lambda *s: torch.randn(*s, dtype=torch.bfloat16) * 0.8)(F, S) * (F ** -0.5)),
            "b2": _w((lambda *s: torch.randn(*s, dtype=torch.bfloat16) * 12.8)(S) * 0.02),
        }
    _B_in = _B_setup()

    return {
        "A_x": _A_in["x"],
        "A_wqkv": _A_in["wqkv"],
        "A_wo": _A_in["wo"],
        "B_x": _B_in["x"],
        "B_w1": _B_in["w1"],
        "B_b1": _B_in["b1"],
        "B_w2": _B_in["w2"],
        "B_b2": _B_in["b2"],
    }

def reference(A_x, A_wqkv, A_wo, B_x, B_w1, B_b1, B_w2, B_b2):
    def _A_ref(x, wqkv, wo):
        B, S, D = x.shape
        H = 32; Dh = D // H
        W, dil = 8, 2
        qkv = (lambda x, *d: x.permute(*d))((x @ wqkv).reshape(B, S, 3, H, Dh), 2, 0, 3, 1, 4)
        q, k, v = qkv[0], qkv[1], qkv[2]
        scale = Dh ** -0.5
        pos = torch.arange(S)
        off = torch.arange(W) * dil
        idx = pos[:, None] - off[None, :]
        mask = idx >= 0
        idx_c = torch.where(mask, idx, 0).reshape(-1)
        kg = k[:, :, idx_c, :].reshape(B, H, S, W, Dh)
        vg = v[:, :, idx_c, :].reshape(B, H, S, W, Dh)
        logits = torch.einsum("bhsd,bhswd->bhsw", q, kg) * scale
        logits = torch.where(mask[None, None, :, :], logits, -1e9)
        attn = _softmax(logits, axis=-1)
        o = torch.einsum("bhsw,bhswd->bhsd", attn, vg)
        return (lambda x, *d: x.permute(*d))(o, 0, 2, 1, 3).reshape(B, S, D) @ wo

    def _B_ref(x, w1, b1, w2, b2):
        B, S, D = x.shape
        h = _layernorm(x, axis=-1)
        u = torch.einsum("bsd,sf->bdf", h, w1) + b1
        u = _gelu(u)
        y = torch.einsum("bdf,fs->bds", u, w2) + b2
        return (lambda x, *d: x.permute(*d))(y, 0, 2, 1)

    x = A_x
    h = x + _A_ref(_layernorm(x, axis=-1), A_wqkv, A_wo)
    h2 = h + _B_ref(_layernorm(h, axis=-1), B_w1, B_b1, B_w2, B_b2)
    return h2
```

```asm
; @launch grid=(256,1,1) block=(256,1,1) lds=163840
.amdgcn_target "amdgcn-amd-amdhsa--gfx950"
.text
.globl sequential_preLN__sliding_local_dilated__mixer_token_mlp__prompt_kernel
.p2align 12
.fill 512, 4, 0xbf810000
.type sequential_preLN__sliding_local_dilated__mixer_token_mlp__prompt_kernel,@function
sequential_preLN__sliding_local_dilated__mixer_token_mlp__prompt_kernel:
    s_load_dwordx2 s[4:5], s[0:1], 0
    s_load_dwordx2 s[8:9], s[0:1], 8
    s_cmp_ge_u32 s2, 256
    s_cbranch_scc1 L_end
    v_lshrrev_b32 v2, 6, v0
    v_and_b32 v1, 63, v0
    v_readfirstlane_b32 s44, v2
    s_getpc_b64 s[46:47]
    s_and_b32 s46, s46, 0xffffff00
    s_lshr_b32 s48, s2, 3
    s_lshl2_add_u32 s48, s48, s44
    s_lshl_b32 s48, s48, 8
    s_min_u32 s48, s48, (L_last-sequential_preLN__sliding_local_dilated__mixer_token_mlp__prompt_kernel)&0xffffff00
    v_and_b32 v4, 1, v0
    v_lshl_add_u32 v4, v4, 7, s48
    global_load_dword v252, v4, s[46:47]
    v_lshrrev_b32 v2, 4, v1
    v_and_b32 v3, 15, v1
    v_lshlrev_b32 v8, 4, v1
    s_mov_b32 s6, 0x200000
    s_mov_b32 s7, 0x20000
    s_mov_b32 s10, 0x180000
    s_mov_b32 s11, 0x20000
    s_lshr_b32 s67, s2, 5
    s_bfe_u32 s46, s2, 131073
    s_lshr_b32 s47, s2, 6
    s_lshl2_add_u32 s46, s46, s47
    s_and_b32 s47, s67, 1
    s_lshl4_add_u32 s54, s47, s46
    s_lshl_b32 s47, s47, 10
    s_bfe_u32 s48, s2, 131075
    s_and_b32 s55, s2, 1
    s_lshl2_add_u32 s55, s55, s48
    s_lshl_b32 s48, s48, 1
    s_xor_b32 s64, s48, s67
    s_cmp_eq_u32 s55, 3
    s_cselect_b32 s51, 7, 4
    s_and_b32 s64, s64, s51
    s_lshr_b32 s51, s2, 1
    s_lshl_b32 s48, s2, 1
    s_xor_b32 s51, s51, s48
    s_and_b32 s51, s51, 3
    s_xor_b32 s64, s64, s51
    s_lshl_b32 s51, s64, 1
    s_lshl2_add_u32 s50, s46, s44
    s_lshl_b32 s50, s50, 15
    s_add_u32 s50, s50, s47
    s_lshl_b32 s48, s64, 7
    s_add_u32 s50, s50, s48
    s_lshl_b32 s46, s46, 17
    s_sub_u32 s46, s46, 16384
    s_max_i32 s46, s46, 0
    s_add_u32 s46, s46, s47
    s_xor_b32 s48, s64, s44
    s_lshl_b32 s48, s48, 7
    s_add_u32 s59, s46, s48
    s_lshl_b32 s62, s44, 14
    s_add_u32 s62, s62, 73728
    s_lshl_b32 s63, s44, 10
    s_add_u32 s63, s63, 139264
    s_mul_i32 s53, s44, 3072
    v_lshrrev_b32 v4, 3, v1
    v_and_b32 v5, 7, v1
    v_xor_b32 v5, v5, v2
    v_lshlrev_b32 v5, 4, v5
    v_lshl_add_u32 v9, v4, 11, v5
    v_xor_b32 v18, 64, v9
    v_add_u32 v18, 15360, v18
    s_lshl_b32 s46, s55, 7
    s_lshl3_add_u32 s46, s53, s46
    v_mov_b32 v5, 3072
    v_mad_u32_u24 v10, v4, v5, s46
    v_lshrrev_b32 v4, 1, v1
    v_and_b32 v5, 1, v2
    s_lshl_b32 s3, s44, 1
    v_xor_b32 v4, v4, v5
    v_xor_b32 v4, s3, v4
    v_and_b32 v4, 3, v4
    v_lshl_add_u32 v10, v4, 5, v10
    v_and_b32 v4, 1, v1
    v_lshl_add_u32 v10, v4, 4, v10
    s_waitcnt lgkmcnt(0)
    s_add_u32 m0, s62, 0
    s_xor_b32 s3, s50, 0
    buffer_load_dwordx4 v9, s[4:7], s3 offen lds
    buffer_load_dwordx4 v18, s[4:7], s3 offen offset:1024 lds
    s_add_u32 m0, s63, 0
    s_xor_b32 s3, s59, 0
    s_mov_b32 exec_lo, 0xffffff00
    buffer_load_dwordx4 v9, s[4:7], s3 offen lds
    s_mov_b32 exec_lo, -1
    s_add_u32 m0, s53, 0
    s_xor_b32 s3, s51, 0
    s_mul_i32 s3, s3, 98304
    buffer_load_dwordx4 v10, s[8:11], s3 offen lds
    buffer_load_dwordx4 v10, s[8:11], s3 offen offset:1024 lds
    buffer_load_dwordx4 v10, s[8:11], s3 offen offset:2048 lds
    s_add_u32 m0, s53, 12288
    s_xor_b32 s3, s51, 1
    s_mul_i32 s3, s3, 98304
    buffer_load_dwordx4 v10, s[8:11], s3 offen lds
    buffer_load_dwordx4 v10, s[8:11], s3 offen offset:1024 lds
    buffer_load_dwordx4 v10, s[8:11], s3 offen offset:2048 lds
    s_add_u32 m0, s62, 2048
    s_xor_b32 s3, s50, 128
    buffer_load_dwordx4 v9, s[4:7], s3 offen lds
    buffer_load_dwordx4 v18, s[4:7], s3 offen offset:1024 lds
    s_add_u32 m0, s53, 24576
    s_xor_b32 s3, s51, 2
    s_mul_i32 s3, s3, 98304
    buffer_load_dwordx4 v10, s[8:11], s3 offen lds
    buffer_load_dwordx4 v10, s[8:11], s3 offen offset:1024 lds
    buffer_load_dwordx4 v10, s[8:11], s3 offen offset:2048 lds
    s_load_dwordx2 s[40:41], s[0:1], 80
    s_load_dwordx2 s[36:37], s[0:1], 72
    s_load_dwordx2 s[12:13], s[0:1], 16
    s_load_dwordx2 s[16:17], s[0:1], 32
    s_load_dwordx2 s[20:21], s[0:1], 40
    s_load_dwordx2 s[24:25], s[0:1], 48
    s_load_dwordx2 s[28:29], s[0:1], 56
    s_load_dwordx2 s[32:33], s[0:1], 64
    s_mov_b32 s42, 0x2000000
    s_mov_b32 s43, 0x20000
    s_mov_b32 s38, 0x100
    s_mov_b32 s39, 0x20000
    s_mov_b32 s14, 0x80000
    s_mov_b32 s15, 0x20000
    s_mov_b32 s18, 0x700000
    s_mov_b32 s19, 0x20000
    s_mov_b32 s22, 0xe00
    s_mov_b32 s23, 0x20000
    s_mov_b32 s26, 0x700000
    s_mov_b32 s27, 0x20000
    s_mov_b32 s30, 0x1000
    s_mov_b32 s31, 0x20000
    s_mov_b32 s34, 0x200000
    s_mov_b32 s35, 0x20000
    s_or_b32 s46, s2, s44
    s_cmp_lg_u32 s46, 0
    s_cbranch_scc1 L_nononce
    s_memrealtime s[46:47]
    v_mov_b32 v5, 0
    s_waitcnt lgkmcnt(0)
    s_or_b32 s46, s46, 1
    v_mov_b32 v4, s46
    s_mov_b64 exec, 1
    buffer_store_dword v4, v5, s[36:39], 0 offen sc1
    s_mov_b64 exec, -1
L_nononce:
    v_mov_b32 v208, 0x3f803f80
    v_mov_b32 v209, 0x3f803f80
    v_mov_b32 v210, 0x3f803f80
    v_mov_b32 v211, 0x3f803f80
    v_lshrrev_b32 v4, 3, v1
    v_and_b32 v5, 7, v1
    v_lshlrev_b32 v5, 4, v5
    v_lshl_add_u32 v4, v4, 10, v5
    v_add_u32 v4, 139264, v4
    ds_write_b128 v4, v[208:211]
    v_lshrrev_b32 v4, 1, v3
    v_xor_b32 v4, v4, v2
    v_lshlrev_b32 v4, 4, v4
    v_lshl_add_u32 v4, v3, 7, v4
    v_add_u32 v16, s62, v4
    v_add_u32 v12, 73728, v4
    v_xor_b32 v241, 64, v16
    v_xor_b32 v240, 64, v12
    v_and_b32 v4, 959, v4
    v_add_u32 v13, 139264, v4
    v_add_u32 v17, s63, v4
    s_xor_b32 s46, s55, s64
    s_lshl_b32 s46, s46, 11
    v_add_u32 v242, s46, v16
    v_add_u32 v243, s46, v241
    v_mul_u32_u24 v14, 3072, v2
    v_bfe_u32 v4, v1, 2, 2
    v_lshl_add_u32 v14, v4, 7, v14
    v_bfe_u32 v4, v1, 3, 2
    v_xor_b32 v4, s44, v4
    v_lshl_add_u32 v14, v4, 5, v14
    v_and_b32 v4, 3, v1
    v_lshl_add_u32 v14, v4, 3, v14
    v_add_u32 v15, 49152, v14
    v_mov_b32 v222, -1
    v_mov_b32 v223, -1
    v_mov_b32 v224, -1
    v_mov_b32 v225, -1
    s_mov_b32 s45, 131072
    v_lshrrev_b32 v4, 5, v1
    v_mul_u32_u24 v4, 15872, v4
    v_mov_b32 v0, v8
    v_add_u32 v253, v4, v8
    s_bitcmp1_b32 s44, 0
    s_cselect_b32 s46, 0, 0x1000080
    s_mov_b32 exec_lo, 0xff000000
    s_mov_b32 exec_hi, 0xff000000
    v_add_u32 v253, s46, v253
    s_mov_b32 exec_hi, 0
    v_add_u32 v0, 0x1000080, v0
    s_mov_b64 exec, -1
    s_lshr_b32 s100, s2, 5
    s_and_b32 s47, s2, 1
    s_sub_u32 s67, s55, s47
    s_cmp_eq_u32 s55, 3
    s_cselect_b32 s67, 7, s67
    s_bfe_u32 s46, s2, 131073
    s_mul_i32 s56, s46, 7
    s_cmp_lt_u32 s67, 7
    s_cselect_b32 s46, s67, 3
    s_add_u32 s56, s56, s46
    s_and_b32 s57, s2, 6
    s_lshl2_add_u32 s57, s57, s55
    s_lshl_b32 s58, s100, 1
    s_mov_b32 s66, 229376
    s_sub_u32 s65, 16, s58
    s_and_b32 s46, s44, 1
    s_lshl_b32 s46, s46, 4
    s_add_u32 s46, s46, s58
    s_lshl_b32 s46, s46, 6
    s_lshr_b32 s47, s44, 1
    s_add_u32 s46, s46, s47
    s_mul_i32 s60, s46, 3584
    s_lshl_b32 s46, s56, 7
    s_add_u32 s60, s60, s46
    s_sub_u32 s61, s60, 3670016
    s_mul_i32 s64, s44, 24576
    s_add_u32 s64, s64, 65536
    s_lshl_b32 s52, s44, 15
    s_lshl_b32 s46, s55, 7
    s_add_u32 s52, s52, s46
    v_mov_b32 v5, 0xf149f2ca
    s_and_b32 s46, s54, 15
    s_cmp_eq_u32 s46, 0
    s_cselect_b32 s46, 0xf149f2ca, 0
    v_lshl_add_u32 v4, v2, 2, 0
    v_sub_u32 v4, v3, v4
    v_cmp_gt_u32 vcc, 8, v4
    s_nop 1
    v_cndmask_b32_e64 v192, v5, 0, vcc
    v_cmp_gt_i32 vcc, -8, v4
    s_nop 1
    v_cndmask_b32_e64 v196, v5, 0, vcc
    v_min_f32 v200, s46, v196
    v_cmp_le_i32 vcc, 0, v4
    s_nop 1
    v_cndmask_b32_e64 v204, 0, -1, vcc
    v_and_b32 v204, 0xffff, v204
    v_lshl_add_u32 v4, v2, 2, 1
    v_sub_u32 v4, v3, v4
    v_cmp_gt_u32 vcc, 8, v4
    s_nop 1
    v_cndmask_b32_e64 v193, v5, 0, vcc
    v_cmp_gt_i32 vcc, -8, v4
    s_nop 1
    v_cndmask_b32_e64 v197, v5, 0, vcc
    v_min_f32 v201, s46, v197
    v_cmp_le_i32 vcc, 0, v4
    s_nop 1
    v_cndmask_b32_e64 v4, 0, -1, vcc
    v_and_b32 v4, 0xffff0000, v4
    v_or_b32 v204, v204, v4
    v_not_b32 v206, v204
    v_lshl_add_u32 v4, v2, 2, 2
    v_sub_u32 v4, v3, v4
    v_cmp_gt_u32 vcc, 8, v4
    s_nop 1
    v_cndmask_b32_e64 v194, v5, 0, vcc
    v_cmp_gt_i32 vcc, -8, v4
    s_nop 1
    v_cndmask_b32_e64 v198, v5, 0, vcc
    v_min_f32 v202, s46, v198
    v_cmp_le_i32 vcc, 0, v4
    s_nop 1
    v_cndmask_b32_e64 v205, 0, -1, vcc
    v_and_b32 v205, 0xffff, v205
    v_lshl_add_u32 v4, v2, 2, 3
    v_sub_u32 v4, v3, v4
    v_cmp_gt_u32 vcc, 8, v4
    s_nop 1
    v_cndmask_b32_e64 v195, v5, 0, vcc
    v_cmp_gt_i32 vcc, -8, v4
    s_nop 1
    v_cndmask_b32_e64 v199, v5, 0, vcc
    v_min_f32 v203, s46, v199
    v_cmp_le_i32 vcc, 0, v4
    s_nop 1
    v_cndmask_b32_e64 v4, 0, -1, vcc
    v_and_b32 v4, 0xffff0000, v4
    v_or_b32 v205, v205, v4
    v_not_b32 v207, v205
    v_lshrrev_b32 v4, 1, v1
    v_xor_b32 v4, v4, v2
    v_and_b32 v4, 3, v4
    v_lshrrev_b32 v5, 3, v1
    v_lshlrev_b32 v11, 10, v5
    v_lshl_add_u32 v11, v4, 5, v11
    v_and_b32 v4, 1, v1
    v_lshl_add_u32 v11, v4, 4, v11
    v_lshrrev_b32 v245, 3, v1
    v_mul_u32_u24 v244, 7168, v245
    v_lshrrev_b32 v245, 1, v1
    v_and_b32 v246, 1, v2
    v_xor_b32 v245, v245, v246
    v_and_b32 v245, 3, v245
    v_lshl_add_u32 v244, v245, 5, v244
    v_and_b32 v245, 1, v1
    v_lshl_add_u32 v244, v245, 4, v244
    v_xor_b32 v245, 64, v244
    v_add_u32 v246, 112640, v244
    v_add_u32 v247, 168960, v245
    v_add_u32 v245, 56320, v245
    v_bfe_u32 v249, v1, 2, 2
    v_lshl_add_u32 v249, v2, 3, v249
    s_and_b32 s3, s44, 1
    s_lshl_b32 s3, s3, 1
    v_lshlrev_b32 v248, 7, v249
    v_bfe_u32 v249, v1, 3, 2
    v_xor_b32 v249, s3, v249
    v_lshl_add_u32 v248, v249, 5, v248
    v_and_b32 v249, 3, v1
    v_lshl_add_u32 v248, v249, 3, v248
    v_add_u32 v248, s64, v248
    v_xor_b32 v249, 32, v248
    v_xor_b32 v250, 64, v248
    v_xor_b32 v251, 96, v248
    s_add_u32 m0, s53, 36864
    s_xor_b32 s3, s51, 3
    s_mul_i32 s3, s3, 98304
    buffer_load_dwordx4 v10, s[8:11], s3 offen lds
    buffer_load_dwordx4 v10, s[8:11], s3 offen offset:1024 lds
    buffer_load_dwordx4 v10, s[8:11], s3 offen offset:2048 lds
    s_add_u32 m0, s62, 4096
    s_xor_b32 s3, s50, 256
    buffer_load_dwordx4 v9, s[4:7], s3 offen lds
    buffer_load_dwordx4 v18, s[4:7], s3 offen offset:1024 lds
    s_add_u32 m0, s53, 49152
    s_xor_b32 s3, s51, 4
    s_mul_i32 s3, s3, 98304
    buffer_load_dwordx4 v10, s[8:11], s3 offen lds
    buffer_load_dwordx4 v10, s[8:11], s3 offen offset:1024 lds
    buffer_load_dwordx4 v10, s[8:11], s3 offen offset:2048 lds
    s_add_u32 m0, s53, 61440
    s_xor_b32 s3, s51, 5
    s_mul_i32 s3, s3, 98304
    buffer_load_dwordx4 v10, s[8:11], s3 offen lds
    buffer_load_dwordx4 v10, s[8:11], s3 offen offset:1024 lds
    buffer_load_dwordx4 v10, s[8:11], s3 offen offset:2048 lds
    s_mov_b64 exec, 0
    s_cmp_eq_u32 s44, 1
    s_cbranch_scc1 L_st2
    s_branch L_pb0
.p2alignl 12, 0xbf810000
L_pb0:
    s_mov_b64 exec, -1
    s_waitcnt vmcnt(14)
    s_waitcnt lgkmcnt(0)
    s_barrier
    ds_read_b64_tr_b16 v[20:21], v14 offset:0
    ds_read_b64_tr_b16 v[22:23], v14 offset:512
    ds_read_b64_tr_b16 v[24:25], v14 offset:1024
    ds_read_b64_tr_b16 v[26:27], v14 offset:1536
    ds_read_b64_tr_b16 v[28:29], v14 offset:2048
    ds_read_b64_tr_b16 v[30:31], v14 offset:2560
    ds_read_b128 v[48:51], v12 offset:0
    ds_read_b128 v[52:55], v12 offset:16384
    ds_read_b128 v[56:59], v12 offset:32768
    ds_read_b128 v[60:63], v12 offset:49152
    ds_read_b128 v[44:47], v13 offset:0
    ds_read_b128 v[68:71], v240 offset:0
    ds_read_b128 v[72:75], v240 offset:16384
    ds_read_b128 v[76:79], v240 offset:32768
    ds_read_b128 v[80:83], v240 offset:49152
    ds_read_b128 v[64:67], v13 offset:64
    s_waitcnt lgkmcnt(5)
    v_mfma_f32_16x16x32_bf16 v[108:111], v[20:23], v[48:51], 0
    ds_read_b64_tr_b16 v[32:33], v14 offset:12288
    s_add_u32 m0, s62, 6144
    s_xor_b32 s3, s50, 384
    v_mfma_f32_16x16x32_bf16 v[112:115], v[20:23], v[52:55], 0
    buffer_load_dwordx4 v9, s[4:7], s3 offen lds
    v_mfma_f32_16x16x32_bf16 v[116:119], v[20:23], v[56:59], 0
    ds_read_b64_tr_b16 v[34:35], v14 offset:12800
    v_mfma_f32_16x16x32_bf16 v[120:123], v[20:23], v[60:63], 0
    ds_read_b64_tr_b16 v[36:37], v14 offset:13312
    v_mfma_f32_16x16x32_bf16 v[104:107], v[20:23], v[44:47], 0
    ds_read_b64_tr_b16 v[38:39], v14 offset:13824
    v_mfma_f32_16x16x32_bf16 v[124:127], v[24:27], v[44:47], 0
    ds_read_b64_tr_b16 v[40:41], v14 offset:14336
    v_mfma_f32_16x16x32_bf16 v[140:143], v[24:27], v[60:63], 0
    ds_read_b64_tr_b16 v[42:43], v14 offset:14848
    v_mfma_f32_16x16x32_bf16 v[136:139], v[24:27], v[56:59], 0
    ds_read_b128 v[172:175], v16 offset:0
    buffer_load_dwordx4 v18, s[4:7], s3 offen offset:1024 lds
    v_mfma_f32_16x16x32_bf16 v[132:135], v[24:27], v[52:55], 0
    ds_read_b128 v[176:179], v241 offset:0
    v_mfma_f32_16x16x32_bf16 v[128:131], v[24:27], v[48:51], 0
    ds_read_b128 v[88:91], v12 offset:2048
    v_mfma_f32_16x16x32_bf16 v[148:151], v[48:51], v[28:31], 0
    ds_read_b128 v[92:95], v12 offset:18432
    v_mfma_f32_16x16x32_bf16 v[152:155], v[52:55], v[28:31], 0
    ds_read_b128 v[96:99], v12 offset:34816
    v_mfma_f32_16x16x32_bf16 v[156:159], v[56:59], v[28:31], 0
    ds_read_b128 v[100:103], v12 offset:51200
    v_mfma_f32_16x16x32_bf16 v[160:163], v[60:63], v[28:31], 0
    ds_read_b128 v[84:87], v13 offset:1024
    v_mfma_f32_16x16x32_bf16 v[144:147], v[44:47], v[28:31], 0
    s_waitcnt vmcnt(13) lgkmcnt(5)
    s_barrier
    v_mfma_f32_16x16x32_bf16 v[108:111], v[32:35], v[68:71], v[108:111]
    ds_read_b64_tr_b16 v[20:21], v14 offset:24576
    s_add_u32 m0, s53, 0
    s_xor_b32 s3, s51, 6
    v_mfma_f32_16x16x32_bf16 v[180:183], v[172:175], v[172:175], 0
    s_mul_i32 s3, s3, 98304
    v_mfma_f32_16x16x32_bf16 v[112:115], v[32:35], v[72:75], v[112:115]
    buffer_load_dwordx4 v10, s[8:11], s3 offen lds
    v_mfma_f32_16x16x32_bf16 v[116:119], v[32:35], v[76:79], v[116:119]
    ds_read_b64_tr_b16 v[22:23], v14 offset:25088
    ds_read_b64_tr_b16 v[24:25], v14 offset:25600
    v_mfma_f32_16x16x32_bf16 v[120:123], v[32:35], v[80:83], v[120:123]
    buffer_load_dwordx4 v10, s[8:11], s3 offen offset:1024 lds
    v_mfma_f32_16x16x32_bf16 v[184:187], v[208:211], v[172:175], 0
    ds_read_b64_tr_b16 v[26:27], v14 offset:26112
    v_mfma_f32_16x16x32_bf16 v[104:107], v[32:35], v[64:67], v[104:107]
    ds_read_b64_tr_b16 v[28:29], v14 offset:26624
    buffer_load_dwordx4 v10, s[8:11], s3 offen offset:2048 lds
    v_mfma_f32_16x16x32_bf16 v[124:127], v[36:39], v[64:67], v[124:127]
    ds_read_b64_tr_b16 v[30:31], v14 offset:27136
    v_mfma_f32_16x16x32_bf16 v[140:143], v[36:39], v[80:83], v[140:143]
    ds_read_b128 v[164:167], v16 offset:2048
    v_mfma_f32_16x16x32_bf16 v[136:139], v[36:39], v[76:79], v[136:139]
    s_add_u32 m0, s53, 12288
    s_xor_b32 s3, s51, 7
    v_mfma_f32_16x16x32_bf16 v[180:183], v[176:179], v[176:179], v[180:183]
    s_mul_i32 s3, s3, 98304
    v_mfma_f32_16x16x32_bf16 v[132:135], v[36:39], v[72:75], v[132:135]
    buffer_load_dwordx4 v10, s[8:11], s3 offen lds
    v_mfma_f32_16x16x32_bf16 v[128:131], v[36:39], v[68:71], v[128:131]
    ds_read_b128 v[168:171], v241 offset:2048
    ds_read_b128 v[48:51], v240 offset:2048
    v_mfma_f32_16x16x32_bf16 v[148:151], v[68:71], v[40:43], v[148:151]
    buffer_load_dwordx4 v10, s[8:11], s3 offen offset:1024 lds
    v_mfma_f32_16x16x32_bf16 v[152:155], v[72:75], v[40:43], v[152:155]
    ds_read_b128 v[52:55], v240 offset:18432
    v_mfma_f32_16x16x32_bf16 v[184:187], v[208:211], v[176:179], v[184:187]
    ds_read_b128 v[56:59], v240 offset:34816
    buffer_load_dwordx4 v10, s[8:11], s3 offen offset:2048 lds
    v_mfma_f32_16x16x32_bf16 v[156:159], v[76:79], v[40:43], v[156:159]
    ds_read_b128 v[60:63], v240 offset:51200
    v_mfma_f32_16x16x32_bf16 v[160:163], v[80:83], v[40:43], v[160:163]
    ds_read_b128 v[44:47], v13 offset:1088
    v_mfma_f32_16x16x32_bf16 v[144:147], v[64:67], v[40:43], v[144:147]
    s_waitcnt vmcnt(14) lgkmcnt(5)
    s_barrier
    v_mfma_f32_16x16x32_bf16 v[108:111], v[20:23], v[88:91], v[108:111]
    ds_read_b64_tr_b16 v[32:33], v14 offset:36864
    s_add_u32 m0, s53, 24576
    v_mfma_f32_16x16x32_bf16 v[180:183], v[164:167], v[164:167], v[180:183]
    s_xor_b32 s3, s51, 8
    v_mfma_f32_16x16x32_bf16 v[112:115], v[20:23], v[92:95], v[112:115]
    s_mul_i32 s3, s3, 98304
    v_mfma_f32_16x16x32_bf16 v[116:119], v[20:23], v[96:99], v[116:119]
    buffer_load_dwordx4 v10, s[8:11], s3 offen lds
    v_mfma_f32_16x16x32_bf16 v[120:123], v[20:23], v[100:103], v[120:123]
    ds_read_b64_tr_b16 v[34:35], v14 offset:37376
    v_mfma_f32_16x16x32_bf16 v[184:187], v[208:211], v[164:167], v[184:187]
    ds_read_b64_tr_b16 v[36:37], v14 offset:37888
    v_mfma_f32_16x16x32_bf16 v[104:107], v[20:23], v[84:87], v[104:107]
    buffer_load_dwordx4 v10, s[8:11], s3 offen offset:1024 lds
    v_mfma_f32_16x16x32_bf16 v[124:127], v[24:27], v[84:87], v[124:127]
    ds_read_b64_tr_b16 v[38:39], v14 offset:38400
    v_mfma_f32_16x16x32_bf16 v[140:143], v[24:27], v[100:103], v[140:143]
    ds_read_b64_tr_b16 v[40:41], v14 offset:38912
    v_mfma_f32_16x16x32_bf16 v[136:139], v[24:27], v[96:99], v[136:139]
    ds_read_b64_tr_b16 v[42:43], v14 offset:39424
    v_mfma_f32_16x16x32_bf16 v[180:183], v[168:171], v[168:171], v[180:183]
    buffer_load_dwordx4 v10, s[8:11], s3 offen offset:2048 lds
    v_mfma_f32_16x16x32_bf16 v[132:135], v[24:27], v[92:95], v[132:135]
    ds_read_b128 v[68:71], v12 offset:4096
    v_mfma_f32_16x16x32_bf16 v[128:131], v[24:27], v[88:91], v[128:131]
    ds_read_b128 v[72:75], v12 offset:20480
    v_mfma_f32_16x16x32_bf16 v[148:151], v[88:91], v[28:31], v[148:151]
    ds_read_b128 v[76:79], v12 offset:36864
    v_mfma_f32_16x16x32_bf16 v[152:155], v[92:95], v[28:31], v[152:155]
    s_add_u32 m0, s63, 4096
    s_xor_b32 s3, s59, 512
    s_mov_b32 exec_lo, 0xffffff00
    buffer_load_dwordx4 v9, s[4:7], s3 offen lds
    s_mov_b32 exec_lo, -1
    v_mfma_f32_16x16x32_bf16 v[184:187], v[208:211], v[168:171], v[184:187]
    ds_read_b128 v[80:83], v12 offset:53248
    v_mfma_f32_16x16x32_bf16 v[156:159], v[96:99], v[28:31], v[156:159]
    ds_read_b128 v[64:67], v13 offset:2048
    v_mfma_f32_16x16x32_bf16 v[160:163], v[100:103], v[28:31], v[160:163]
    v_mfma_f32_16x16x32_bf16 v[144:147], v[84:87], v[28:31], v[144:147]
    s_waitcnt vmcnt(15) lgkmcnt(5)
    s_barrier
    v_mfma_f32_16x16x32_bf16 v[108:111], v[32:35], v[48:51], v[108:111]
    ds_read_b64_tr_b16 v[20:21], v15 offset:0
    s_add_u32 m0, s53, 36864
    s_xor_b32 s3, s51, 9
    v_mfma_f32_16x16x32_bf16 v[112:115], v[32:35], v[52:55], v[112:115]
    s_mul_i32 s3, s3, 98304
    buffer_load_dwordx4 v10, s[8:11], s3 offen lds
    v_mfma_f32_16x16x32_bf16 v[116:119], v[32:35], v[56:59], v[116:119]
    ds_read_b64_tr_b16 v[22:23], v15 offset:512
    v_mfma_f32_16x16x32_bf16 v[120:123], v[32:35], v[60:63], v[120:123]
    ds_read_b64_tr_b16 v[24:25], v15 offset:1024
    buffer_load_dwordx4 v10, s[8:11], s3 offen offset:1024 lds
    v_mfma_f32_16x16x32_bf16 v[104:107], v[32:35], v[44:47], v[104:107]
    ds_read_b64_tr_b16 v[26:27], v15 offset:1536
    v_mfma_f32_16x16x32_bf16 v[124:127], v[36:39], v[44:47], v[124:127]
    ds_read_b64_tr_b16 v[28:29], v15 offset:2048
    ds_read_b64_tr_b16 v[30:31], v15 offset:2560
    v_mfma_f32_16x16x32_bf16 v[140:143], v[36:39], v[60:63], v[140:143]
    buffer_load_dwordx4 v10, s[8:11], s3 offen offset:2048 lds
    v_mfma_f32_16x16x32_bf16 v[136:139], v[36:39], v[56:59], v[136:139]
    ds_read_b128 v[164:167], v17 offset:0
    ds_read_b128 v[168:171], v17 offset:64
    v_mfma_f32_16x16x32_bf16 v[132:135], v[36:39], v[52:55], v[132:135]
    s_add_u32 m0, s62, 8192
    v_mfma_f32_16x16x32_bf16 v[128:131], v[36:39], v[48:51], v[128:131]
    s_xor_b32 s3, s50, 512
    buffer_load_dwordx4 v9, s[4:7], s3 offen lds
    v_mfma_f32_16x16x32_bf16 v[148:151], v[48:51], v[40:43], v[148:151]
    ds_read_b128 v[88:91], v240 offset:4096
    v_mfma_f32_16x16x32_bf16 v[152:155], v[52:55], v[40:43], v[152:155]
    ds_read_b128 v[92:95], v240 offset:20480
    ds_read_b128 v[96:99], v240 offset:36864
    v_mfma_f32_16x16x32_bf16 v[156:159], v[56:59], v[40:43], v[156:159]
    buffer_load_dwordx4 v18, s[4:7], s3 offen offset:1024 lds
    v_mfma_f32_16x16x32_bf16 v[160:163], v[60:63], v[40:43], v[160:163]
    ds_read_b128 v[100:103], v240 offset:53248
    ds_read_b128 v[84:87], v13 offset:2112
    v_mfma_f32_16x16x32_bf16 v[144:147], v[44:47], v[40:43], v[144:147]
    s_waitcnt vmcnt(15) lgkmcnt(5)
    s_barrier
    v_mfma_f32_16x16x32_bf16 v[108:111], v[20:23], v[68:71], v[108:111]
    ds_read_b64_tr_b16 v[32:33], v15 offset:12288
    s_add_u32 m0, s53, 49152
    s_xor_b32 s3, s51, 10
    v_mfma_f32_16x16x32_bf16 v[188:191], v[164:167], v[164:167], 0
    s_mul_i32 s3, s3, 98304
    buffer_load_dwordx4 v10, s[8:11], s3 offen lds
    v_mfma_f32_16x16x32_bf16 v[112:115], v[20:23], v[72:75], v[112:115]
    ds_read_b64_tr_b16 v[34:35], v15 offset:12800
    ds_read_b64_tr_b16 v[36:37], v15 offset:13312
    v_mfma_f32_16x16x32_bf16 v[116:119], v[20:23], v[76:79], v[116:119]
    buffer_load_dwordx4 v10, s[8:11], s3 offen offset:1024 lds
    v_mfma_f32_16x16x32_bf16 v[120:123], v[20:23], v[80:83], v[120:123]
    ds_read_b64_tr_b16 v[38:39], v15 offset:13824
    ds_read_b64_tr_b16 v[40:41], v15 offset:14336
    v_mfma_f32_16x16x32_bf16 v[104:107], v[20:23], v[64:67], v[104:107]
    buffer_load_dwordx4 v10, s[8:11], s3 offen offset:2048 lds
    ds_read_b64_tr_b16 v[42:43], v15 offset:14848
    v_mfma_f32_16x16x32_bf16 v[124:127], v[24:27], v[64:67], v[124:127]
    ds_read_b128 v[172:175], v16 offset:4096
    v_mfma_f32_16x16x32_bf16 v[140:143], v[24:27], v[80:83], v[140:143]
    s_add_u32 m0, s62, 10240
    s_xor_b32 s3, s50, 640
    v_mfma_f32_16x16x32_bf16 v[136:139], v[24:27], v[76:79], v[136:139]
    buffer_load_dwordx4 v9, s[4:7], s3 offen lds
    ds_read_b128 v[176:179], v241 offset:4096
    v_mfma_f32_16x16x32_bf16 v[188:191], v[168:171], v[168:171], v[188:191]
    ds_read_b128 v[48:51], v12 offset:6144
    buffer_load_dwordx4 v18, s[4:7], s3 offen offset:1024 lds
    v_mfma_f32_16x16x32_bf16 v[132:135], v[24:27], v[72:75], v[132:135]
    ds_read_b128 v[52:55], v12 offset:22528
    v_mfma_f32_16x16x32_bf16 v[128:131], v[24:27], v[68:71], v[128:131]
    ds_read_b128 v[56:59], v12 offset:38912
    s_lshl2_add_u32 s3, s54, s44
    v_mfma_f32_16x16x32_bf16 v[148:151], v[68:71], v[28:31], v[148:151]
    s_lshl_b32 s3, s3, 3
    s_add_u32 s3, s3, s55
    v_mfma_f32_16x16x32_bf16 v[152:155], v[72:75], v[28:31], v[152:155]
    s_lshl_b32 s3, s3, 11
    v_mfma_f32_16x16x32_bf16 v[156:159], v[76:79], v[28:31], v[156:159]
    buffer_store_dwordx4 v[222:225], v0, s[40:43], s3 offen offset:0 sc1
    buffer_store_dwordx4 v[222:225], v0, s[40:43], s3 offen offset:1024 sc1
    v_mfma_f32_16x16x32_bf16 v[160:163], v[80:83], v[28:31], v[160:163]
    ds_read_b128 v[60:63], v12 offset:55296
    ds_read_b128 v[44:47], v13 offset:3072
    v_mfma_f32_16x16x32_bf16 v[144:147], v[64:67], v[28:31], v[144:147]
    s_waitcnt vmcnt(19) lgkmcnt(5)
    s_barrier
    v_mfma_f32_16x16x32_bf16 v[108:111], v[32:35], v[88:91], v[108:111]
    ds_read_b64_tr_b16 v[20:21], v14 offset:0
    v_lshlrev_b32 v19, 2, v1
    s_add_u32 m0, s53, 61440
    v_mfma_f32_16x16x32_bf16 v[180:183], v[172:175], v[172:175], v[180:183]
    s_xor_b32 s3, s51, 11
    s_mul_i32 s3, s3, 98304
    v_mfma_f32_16x16x32_bf16 v[112:115], v[32:35], v[92:95], v[112:115]
    buffer_load_dwordx4 v10, s[8:11], s3 offen lds
    s_lshl_b32 s46, s44, 9
    v_mfma_f32_16x16x32_bf16 v[116:119], v[32:35], v[96:99], v[116:119]
    ds_read_b64_tr_b16 v[22:23], v14 offset:512
    v_mfma_f32_16x16x32_bf16 v[120:123], v[32:35], v[100:103], v[120:123]
    ds_read_b64_tr_b16 v[24:25], v14 offset:1024
    s_add_u32 s46, s46, 150016
    v_mfma_f32_16x16x32_bf16 v[184:187], v[208:211], v[172:175], v[184:187]
    buffer_load_dwordx4 v10, s[8:11], s3 offen offset:1024 lds
    ds_read_b64_tr_b16 v[26:27], v14 offset:1536
    v_mfma_f32_16x16x32_bf16 v[104:107], v[32:35], v[84:87], v[104:107]
    v_add_u32 v4, s46, v19
    ds_read_b64_tr_b16 v[28:29], v14 offset:2048
    v_mfma_f32_16x16x32_bf16 v[124:127], v[36:39], v[84:87], v[124:127]
    ds_read_b64_tr_b16 v[30:31], v14 offset:2560
    v_mfma_f32_16x16x32_bf16 v[140:143], v[36:39], v[100:103], v[140:143]
    v_lshrrev_b32 v5, 2, v3
    buffer_load_dwordx4 v10, s[8:11], s3 offen offset:2048 lds
    v_mfma_f32_16x16x32_bf16 v[136:139], v[36:39], v[96:99], v[136:139]
    ds_read_b128 v[164:167], v16 offset:6144
    v_lshl_add_u32 v5, v5, 4, v3
    v_mfma_f32_16x16x32_bf16 v[180:183], v[176:179], v[176:179], v[180:183]
    ds_read_b128 v[168:171], v241 offset:6144
    v_lshlrev_b32 v5, 2, v5
    v_mfma_f32_16x16x32_bf16 v[132:135], v[36:39], v[92:95], v[132:135]
    s_add_u32 m0, s62, 12288
    v_mfma_f32_16x16x32_bf16 v[128:131], v[36:39], v[88:91], v[128:131]
    s_xor_b32 s3, s50, 768
    buffer_load_dwordx4 v9, s[4:7], s3 offen lds
    v_mfma_f32_16x16x32_bf16 v[148:151], v[88:91], v[40:43], v[148:151]
    ds_read_b128 v[68:71], v240 offset:6144
    v_add_u32 v5, 147456, v5
    v_mfma_f32_16x16x32_bf16 v[152:155], v[92:95], v[40:43], v[152:155]
    ds_read_b128 v[72:75], v240 offset:22528
    ds_read_b128 v[76:79], v240 offset:38912
    v_mfma_f32_16x16x32_bf16 v[184:187], v[208:211], v[176:179], v[184:187]
    v_lshlrev_b32 v6, 2, v3
    v_mfma_f32_16x16x32_bf16 v[156:159], v[96:99], v[40:43], v[156:159]
    buffer_load_dwordx4 v18, s[4:7], s3 offen offset:1024 lds
    ds_read_b128 v[80:83], v240 offset:55296
    v_mfma_f32_16x16x32_bf16 v[160:163], v[100:103], v[40:43], v[160:163]
    v_add_u32 v6, 147456, v6
    ds_read_b128 v[64:67], v13 offset:3136
    v_mfma_f32_16x16x32_bf16 v[144:147], v[84:87], v[40:43], v[144:147]
    s_waitcnt vmcnt(12) lgkmcnt(5)
    s_barrier
    v_mfma_f32_16x16x32_bf16 v[108:111], v[20:23], v[48:51], v[108:111]
    ds_read_b64_tr_b16 v[32:33], v14 offset:12288
    s_add_u32 m0, s53, 0
    s_xor_b32 s3, s51, 12
    v_mfma_f32_16x16x32_bf16 v[180:183], v[164:167], v[164:167], v[180:183]
    s_mul_i32 s3, s3, 98304
    v_mfma_f32_16x16x32_bf16 v[112:115], v[20:23], v[52:55], v[112:115]
    buffer_load_dwordx4 v10, s[8:11], s3 offen lds
    v_mfma_f32_16x16x32_bf16 v[116:119], v[20:23], v[56:59], v[116:119]
    ds_read_b64_tr_b16 v[34:35], v14 offset:12800
    v_mfma_f32_16x16x32_bf16 v[120:123], v[20:23], v[60:63], v[120:123]
    ds_read_b64_tr_b16 v[36:37], v14 offset:13312
    buffer_load_dwordx4 v10, s[8:11], s3 offen offset:1024 lds
    v_mfma_f32_16x16x32_bf16 v[184:187], v[208:211], v[164:167], v[184:187]
    ds_read_b64_tr_b16 v[38:39], v14 offset:13824
    v_mfma_f32_16x16x32_bf16 v[104:107], v[20:23], v[44:47], v[104:107]
    ds_read_b64_tr_b16 v[40:41], v14 offset:14336
    v_mfma_f32_16x16x32_bf16 v[124:127], v[24:27], v[44:47], v[124:127]
    ds_read_b64_tr_b16 v[42:43], v14 offset:14848
    v_mfma_f32_16x16x32_bf16 v[140:143], v[24:27], v[60:63], v[140:143]
    buffer_load_dwordx4 v10, s[8:11], s3 offen offset:2048 lds
    v_mfma_f32_16x16x32_bf16 v[136:139], v[24:27], v[56:59], v[136:139]
    ds_read_b128 v[172:175], v17 offset:4096
    ds_read_b128 v[176:179], v17 offset:4160
    v_mfma_f32_16x16x32_bf16 v[180:183], v[168:171], v[168:171], v[180:183]
    s_add_u32 m0, s62, 14336
    v_mfma_f32_16x16x32_bf16 v[132:135], v[24:27], v[52:55], v[132:135]
    s_xor_b32 s3, s50, 896
    v_mfma_f32_16x16x32_bf16 v[128:131], v[24:27], v[48:51], v[128:131]
    buffer_load_dwordx4 v9, s[4:7], s3 offen lds
    v_mfma_f32_16x16x32_bf16 v[148:151], v[48:51], v[28:31], v[148:151]
    ds_read_b128 v[88:91], v12 offset:8192
    v_mfma_f32_16x16x32_bf16 v[152:155], v[52:55], v[28:31], v[152:155]
    ds_read_b128 v[92:95], v12 offset:24576
    ds_read_b128 v[96:99], v12 offset:40960
    v_mfma_f32_16x16x32_bf16 v[184:187], v[208:211], v[168:171], v[184:187]
    buffer_load_dwordx4 v18, s[4:7], s3 offen offset:1024 lds
    v_mfma_f32_16x16x32_bf16 v[156:159], v[56:59], v[28:31], v[156:159]
    ds_read_b128 v[100:103], v12 offset:57344
    v_mfma_f32_16x16x32_bf16 v[160:163], v[60:63], v[28:31], v[160:163]
    ds_read_b128 v[84:87], v13 offset:4096
    v_mfma_f32_16x16x32_bf16 v[144:147], v[44:47], v[28:31], v[144:147]
    s_waitcnt lgkmcnt(5)
    s_barrier
    v_mfma_f32_16x16x32_bf16 v[108:111], v[32:35], v[68:71], v[108:111]
    ds_read_b64_tr_b16 v[20:21], v14 offset:24576
    s_add_u32 m0, s53, 12288
    s_xor_b32 s3, s51, 13
    v_mfma_f32_16x16x32_bf16 v[188:191], v[172:175], v[172:175], v[188:191]
    s_mul_i32 s3, s3, 98304
    buffer_load_dwordx4 v10, s[8:11], s3 offen lds
    v_mfma_f32_16x16x32_bf16 v[112:115], v[32:35], v[72:75], v[112:115]
    ds_read_b64_tr_b16 v[22:23], v14 offset:25088
    ds_read_b64_tr_b16 v[24:25], v14 offset:25600
    v_mfma_f32_16x16x32_bf16 v[116:119], v[32:35], v[76:79], v[116:119]
    ds_read_b64_tr_b16 v[26:27], v14 offset:26112
    v_mfma_f32_16x16x32_bf16 v[120:123], v[32:35], v[80:83], v[120:123]
    buffer_load_dwordx4 v10, s[8:11], s3 offen offset:1024 lds
    ds_read_b64_tr_b16 v[28:29], v14 offset:26624
    v_mfma_f32_16x16x32_bf16 v[104:107], v[32:35], v[64:67], v[104:107]
    ds_read_b64_tr_b16 v[30:31], v14 offset:27136
    ds_read_b128 v[164:167], v16 offset:8192
    v_mfma_f32_16x16x32_bf16 v[124:127], v[36:39], v[64:67], v[124:127]
    buffer_load_dwordx4 v10, s[8:11], s3 offen offset:2048 lds
    v_mfma_f32_16x16x32_bf16 v[140:143], v[36:39], v[80:83], v[140:143]
    ds_read_b128 v[168:171], v241 offset:8192
    ds_read_b128 v[48:51], v240 offset:8192
    v_mfma_f32_16x16x32_bf16 v[136:139], v[36:39], v[76:79], v[136:139]
    ds_read_b128 v[52:55], v240 offset:24576
    s_lshr_b32 s49, s44, 1
    v_mfma_f32_16x16x32_bf16 v[188:191], v[176:179], v[176:179], v[188:191]
    s_lshl1_add_u32 s3, s55, s49
    s_lshl_b32 s3, s3, 5
    v_mfma_f32_16x16x32_bf16 v[132:135], v[36:39], v[72:75], v[132:135]
    s_add_u32 s3, s3, s54
    v_mfma_f32_16x16x32_bf16 v[128:131], v[36:39], v[68:71], v[128:131]
    s_and_b32 s49, s44, 1
    s_lshl1_add_u32 s3, s3, s49
    v_mfma_f32_16x16x32_bf16 v[148:151], v[68:71], v[40:43], v[148:151]
    s_lshl_b32 s3, s3, 11
    s_add_u32 s3, s3, 0x200000
    v_mfma_f32_16x16x32_bf16 v[152:155], v[72:75], v[40:43], v[152:155]
    buffer_store_dwordx4 v[222:225], v0, s[40:43], s3 offen offset:0 sc1
    v_mfma_f32_16x16x32_bf16 v[156:159], v[76:79], v[40:43], v[156:159]
    buffer_store_dwordx4 v[222:225], v0, s[40:43], s3 offen offset:1024 sc1
    ds_read_b128 v[56:59], v240 offset:40960
    v_mfma_f32_16x16x32_bf16 v[160:163], v[80:83], v[40:43], v[160:163]
    ds_read_b128 v[60:63], v240 offset:57344
    ds_read_b128 v[44:47], v13 offset:4160
    v_mfma_f32_16x16x32_bf16 v[144:147], v[64:67], v[40:43], v[144:147]
    s_waitcnt vmcnt(17) lgkmcnt(5)
    s_barrier
    v_mfma_f32_16x16x32_bf16 v[108:111], v[20:23], v[88:91], v[108:111]
    ds_read_b64_tr_b16 v[32:33], v14 offset:36864
    s_mov_b32 vcc_lo, 0x22222222
    s_mov_b32 vcc_hi, 0x22222222
    v_mfma_f32_16x16x32_bf16 v[180:183], v[164:167], v[164:167], v[180:183]
    v_cndmask_b32 v189, v188, v189, vcc
    s_add_u32 m0, s53, 24576
    v_mfma_f32_16x16x32_bf16 v[112:115], v[20:23], v[92:95], v[112:115]
    s_xor_b32 s3, s51, 14
    v_mfma_f32_16x16x32_bf16 v[116:119], v[20:23], v[96:99], v[116:119]
    s_mul_i32 s3, s3, 98304
    buffer_load_dwordx4 v10, s[8:11], s3 offen lds
    v_mfma_f32_16x16x32_bf16 v[120:123], v[20:23], v[100:103], v[120:123]
    ds_read_b64_tr_b16 v[34:35], v14 offset:37376
    v_mfma_f32_16x16x32_bf16 v[184:187], v[208:211], v[164:167], v[184:187]
    ds_read_b64_tr_b16 v[36:37], v14 offset:37888
    ds_read_b64_tr_b16 v[38:39], v14 offset:38400
    v_mfma_f32_16x16x32_bf16 v[104:107], v[20:23], v[84:87], v[104:107]
    s_mov_b32 vcc_lo, 0x44444444
    v_mfma_f32_16x16x32_bf16 v[124:127], v[24:27], v[84:87], v[124:127]
    s_mov_b32 vcc_hi, 0x44444444
    v_cndmask_b32 v189, v189, v190, vcc
    v_mfma_f32_16x16x32_bf16 v[140:143], v[24:27], v[100:103], v[140:143]
    ds_read_b64_tr_b16 v[40:41], v14 offset:38912
    v_mfma_f32_16x16x32_bf16 v[136:139], v[24:27], v[96:99], v[136:139]
    buffer_load_dwordx4 v10, s[8:11], s3 offen offset:1024 lds
    ds_read_b64_tr_b16 v[42:43], v14 offset:39424
    v_mfma_f32_16x16x32_bf16 v[180:183], v[168:171], v[168:171], v[180:183]
    ds_read_b128 v[172:175], v16 offset:10240
    v_mfma_f32_16x16x32_bf16 v[132:135], v[24:27], v[92:95], v[132:135]
    s_mov_b32 vcc_lo, 0x88888888
    s_mov_b32 vcc_hi, 0x88888888
    v_mfma_f32_16x16x32_bf16 v[128:131], v[24:27], v[88:91], v[128:131]
    v_cndmask_b32 v189, v189, v191, vcc
    v_mfma_f32_16x16x32_bf16 v[148:151], v[88:91], v[28:31], v[148:151]
    ds_read_b128 v[176:179], v241 offset:10240
    ds_read_b128 v[68:71], v12 offset:10240
    v_mfma_f32_16x16x32_bf16 v[152:155], v[92:95], v[28:31], v[152:155]
    buffer_load_dwordx4 v10, s[8:11], s3 offen offset:2048 lds
    v_mfma_f32_16x16x32_bf16 v[184:187], v[208:211], v[168:171], v[184:187]
    ds_read_b128 v[72:75], v12 offset:26624
    ds_write2st64_b32 v4, v188, v189 offset0:0 offset1:1
    v_mfma_f32_16x16x32_bf16 v[156:159], v[96:99], v[28:31], v[156:159]
    ds_read_b128 v[76:79], v12 offset:43008
    v_mfma_f32_16x16x32_bf16 v[160:163], v[100:103], v[28:31], v[160:163]
    ds_read_b128 v[80:83], v12 offset:59392
    ds_read_b128 v[64:67], v13 offset:5120
    v_mfma_f32_16x16x32_bf16 v[144:147], v[84:87], v[28:31], v[144:147]
    s_waitcnt vmcnt(13) lgkmcnt(3)
    s_barrier
    v_mfma_f32_16x16x32_bf16 v[108:111], v[32:35], v[48:51], v[108:111]
    ds_read_b64_tr_b16 v[20:21], v15 offset:0
    ds_read2st64_b32 v[212:213], v6 offset0:10 offset1:12
    s_add_u32 m0, s53, 36864
    v_mfma_f32_16x16x32_bf16 v[180:183], v[172:175], v[172:175], v[180:183]
    s_xor_b32 s3, s51, 15
    s_mul_i32 s3, s3, 98304
    v_mfma_f32_16x16x32_bf16 v[112:115], v[32:35], v[52:55], v[112:115]
    buffer_load_dwordx4 v10, s[8:11], s3 offen lds
    ds_read_b64_tr_b16 v[22:23], v15 offset:512
    v_mfma_f32_16x16x32_bf16 v[116:119], v[32:35], v[56:59], v[116:119]
    ds_read_b64_tr_b16 v[24:25], v15 offset:1024
    buffer_load_dwordx4 v10, s[8:11], s3 offen offset:1024 lds
    v_mfma_f32_16x16x32_bf16 v[120:123], v[32:35], v[60:63], v[120:123]
    ds_read2st64_b32 v[214:215], v6 offset0:14 offset1:16
    ds_read_b64_tr_b16 v[26:27], v15 offset:1536
    v_mfma_f32_16x16x32_bf16 v[184:187], v[208:211], v[172:175], v[184:187]
    ds_read_b64_tr_b16 v[28:29], v15 offset:2048
    ds_read_b64_tr_b16 v[30:31], v15 offset:2560
    v_mfma_f32_16x16x32_bf16 v[104:107], v[32:35], v[44:47], v[104:107]
    buffer_load_dwordx4 v10, s[8:11], s3 offen offset:2048 lds
    ds_read_b128 v[164:167], v16 offset:12288
    v_mfma_f32_16x16x32_bf16 v[124:127], v[36:39], v[44:47], v[124:127]
    ds_read2st64_b32 v[216:217], v5 offset0:11 offset1:13
    ds_read_b128 v[168:171], v241 offset:12288
    v_mfma_f32_16x16x32_bf16 v[140:143], v[36:39], v[60:63], v[140:143]
    v_lshlrev_b32 v7, 10, v3
    s_lshr_b32 s3, s2, 5
    v_mfma_f32_16x16x32_bf16 v[136:139], v[36:39], v[56:59], v[136:139]
    s_lshl2_add_u32 s3, s3, s44
    s_lshl_b32 s3, s3, 14
    v_mfma_f32_16x16x32_bf16 v[180:183], v[176:179], v[176:179], v[180:183]
    s_lshl_b32 s49, s55, 7
    s_add_u32 s3, s3, s49
    v_mfma_f32_16x16x32_bf16 v[132:135], v[36:39], v[52:55], v[132:135]
    buffer_load_dword v252, v7, s[12:15], s3 offen
    ds_read_b128 v[88:91], v240 offset:10240
    v_mfma_f32_16x16x32_bf16 v[128:131], v[36:39], v[48:51], v[128:131]
    ds_read_b128 v[92:95], v240 offset:26624
    ds_read2st64_b32 v[218:219], v5 offset0:15 offset1:17
    v_mfma_f32_16x16x32_bf16 v[148:151], v[48:51], v[40:43], v[148:151]
    ds_read_b128 v[96:99], v240 offset:43008
    s_lshl2_add_u32 s3, s54, s44
    v_mfma_f32_16x16x32_bf16 v[152:155], v[52:55], v[40:43], v[152:155]
    s_lshl_b32 s3, s3, 3
    s_add_u32 s3, s3, s55
    v_mfma_f32_16x16x32_bf16 v[184:187], v[208:211], v[176:179], v[184:187]
    s_lshl_b32 s3, s3, 8
    s_add_u32 s3, s3, 0x800000
    v_mfma_f32_16x16x32_bf16 v[156:159], v[56:59], v[40:43], v[156:159]
    v_lshlrev_b32 v7, 2, v1
    buffer_store_dword v222, v7, s[40:43], s3 offen sc1
    v_mfma_f32_16x16x32_bf16 v[160:163], v[60:63], v[40:43], v[160:163]
    ds_read_b128 v[100:103], v240 offset:59392
    ds_read_b128 v[84:87], v13 offset:5184
    v_mfma_f32_16x16x32_bf16 v[144:147], v[44:47], v[40:43], v[144:147]
    s_waitcnt vmcnt(13) lgkmcnt(3)
    s_barrier
    v_mfma_f32_16x16x32_bf16 v[108:111], v[20:23], v[68:71], v[108:111]
    ds_read_b64_tr_b16 v[32:33], v15 offset:12288
    v_add_f32 v212, v212, v213
    s_lshl_b32 s53, s44, 12
    v_mfma_f32_16x16x32_bf16 v[180:183], v[164:167], v[164:167], v[180:183]
    ds_read_b64_tr_b16 v[34:35], v15 offset:12800
    v_add_f32 v214, v214, v215
    v_mfma_f32_16x16x32_bf16 v[112:115], v[20:23], v[72:75], v[112:115]
    ds_read_b64_tr_b16 v[36:37], v15 offset:13312
    ds_read_b64_tr_b16 v[38:39], v15 offset:13824
    v_mfma_f32_16x16x32_bf16 v[116:119], v[20:23], v[76:79], v[116:119]
    ds_read_b64_tr_b16 v[40:41], v15 offset:14336
    v_mfma_f32_16x16x32_bf16 v[120:123], v[20:23], v[80:83], v[120:123]
    v_add_f32 v216, v216, v217
    v_bfe_u32 v255, v1, 2, 4
    v_mfma_f32_16x16x32_bf16 v[184:187], v[208:211], v[164:167], v[184:187]
    v_min_u32 v255, 13, v255
    s_lshr_b32 s3, s2, 3
    v_mfma_f32_16x16x32_bf16 v[104:107], v[20:23], v[64:67], v[104:107]
    s_lshl2_add_u32 s3, s3, s44
    v_mfma_f32_16x16x32_bf16 v[124:127], v[24:27], v[64:67], v[124:127]
    s_mul_i32 s3, s3, 112
    s_and_b32 s49, s2, 7
    v_mfma_f32_16x16x32_bf16 v[140:143], v[24:27], v[80:83], v[140:143]
    s_add_u32 s3, s3, s49
    s_lshl_b32 s3, s3, 9
    v_mfma_f32_16x16x32_bf16 v[136:139], v[24:27], v[76:79], v[136:139]
    v_lshl_add_u32 v255, v255, 12, s3
    v_mfma_f32_16x16x32_bf16 v[180:183], v[168:171], v[168:171], v[180:183]
    v_and_b32 v7, 3, v1
    v_lshl_add_u32 v255, v7, 7, v255
    v_mfma_f32_16x16x32_bf16 v[132:135], v[24:27], v[72:75], v[132:135]
    ds_read_b64_tr_b16 v[42:43], v15 offset:14848
    ds_read_b128 v[172:175], v16 offset:14336
    v_mfma_f32_16x16x32_bf16 v[128:131], v[24:27], v[68:71], v[128:131]
    v_add_f32 v218, v218, v219
    v_mfma_f32_16x16x32_bf16 v[148:151], v[68:71], v[28:31], v[148:151]
    ds_read_b128 v[176:179], v241 offset:14336
    ds_read_b128 v[48:51], v12 offset:12288
    v_mfma_f32_16x16x32_bf16 v[152:155], v[72:75], v[28:31], v[152:155]
    v_add_f32 v212, v212, v214
    buffer_load_dword v252, v255, s[24:27], 0 offen
    v_mfma_f32_16x16x32_bf16 v[184:187], v[208:211], v[168:171], v[184:187]
    ds_read_b128 v[52:55], v12 offset:28672
    v_mfma_f32_16x16x32_bf16 v[156:159], v[76:79], v[28:31], v[156:159]
    ds_read_b128 v[56:59], v12 offset:45056
    v_add_f32 v216, v216, v218
    v_mfma_f32_16x16x32_bf16 v[160:163], v[80:83], v[28:31], v[160:163]
    ds_read_b128 v[60:63], v12 offset:61440
    ds_read_b128 v[44:47], v13 offset:6144
    v_mfma_f32_16x16x32_bf16 v[144:147], v[64:67], v[28:31], v[144:147]
    s_waitcnt vmcnt(6) lgkmcnt(5)
    s_barrier
    v_mfma_f32_16x16x32_bf16 v[108:111], v[32:35], v[88:91], v[108:111]
    ds_read_b64_tr_b16 v[20:21], v14 offset:0
    v_mul_f32 v212, 0xbb000000, v212
    ds_read_b64_tr_b16 v[22:23], v14 offset:512
    v_mfma_f32_16x16x32_bf16 v[180:183], v[172:175], v[172:175], v[180:183]
    v_mul_f32 v213, v212, v212
    v_mfma_f32_16x16x32_bf16 v[112:115], v[32:35], v[92:95], v[112:115]
    ds_read_b64_tr_b16 v[24:25], v14 offset:1024
    v_mfma_f32_16x16x32_bf16 v[116:119], v[32:35], v[96:99], v[116:119]
    v_mul_f32 v216, 0x3b000000, v216
    v_mfma_f32_16x16x32_bf16 v[120:123], v[32:35], v[100:103], v[120:123]
    ds_read_b64_tr_b16 v[26:27], v14 offset:1536
    v_mfma_f32_16x16x32_bf16 v[184:187], v[208:211], v[172:175], v[184:187]
    v_sub_f32 v216, v216, v213
    v_mfma_f32_16x16x32_bf16 v[104:107], v[32:35], v[84:87], v[104:107]
    ds_read_b64_tr_b16 v[28:29], v14 offset:2048
    v_mfma_f32_16x16x32_bf16 v[124:127], v[36:39], v[84:87], v[124:127]
L_st2:
    s_cbranch_execz L_pb0
    v_max_f32 v216, 0, v216
    v_mfma_f32_16x16x32_bf16 v[140:143], v[36:39], v[100:103], v[140:143]
    ds_read_b64_tr_b16 v[30:31], v14 offset:2560
    v_mfma_f32_16x16x32_bf16 v[136:139], v[36:39], v[96:99], v[136:139]
    ds_read_b128 v[68:71], v240 offset:12288
    v_mfma_f32_16x16x32_bf16 v[180:183], v[176:179], v[176:179], v[180:183]
    v_add_f32 v216, 0x3727c5ac, v216
    v_mfma_f32_16x16x32_bf16 v[132:135], v[36:39], v[92:95], v[132:135]
    ds_read_b128 v[72:75], v240 offset:28672
    v_mfma_f32_16x16x32_bf16 v[128:131], v[36:39], v[88:91], v[128:131]
    v_rsq_f32 v216, v216
    v_mfma_f32_16x16x32_bf16 v[148:151], v[88:91], v[40:43], v[148:151]
    ds_read_b128 v[76:79], v240 offset:45056
    v_mfma_f32_16x16x32_bf16 v[152:155], v[92:95], v[40:43], v[152:155]
    v_add_u32 v4, 147456, v19
    v_mfma_f32_16x16x32_bf16 v[184:187], v[208:211], v[176:179], v[184:187]
    ds_read_b128 v[80:83], v240 offset:61440
    v_mfma_f32_16x16x32_bf16 v[156:159], v[96:99], v[40:43], v[156:159]
    ds_write2st64_b32 v4, v212, v216 offset0:0 offset1:5
    v_mfma_f32_16x16x32_bf16 v[160:163], v[100:103], v[40:43], v[160:163]
    ds_read_b128 v[64:67], v13 offset:6208
    v_mfma_f32_16x16x32_bf16 v[144:147], v[84:87], v[40:43], v[144:147]
    s_waitcnt lgkmcnt(6)
    v_mfma_f32_16x16x32_bf16 v[108:111], v[20:23], v[48:51], v[108:111]
    ds_read_b64_tr_b16 v[32:33], v14 offset:12288
    s_mov_b32 vcc_lo, 0x22222222
    s_mov_b32 vcc_hi, 0x22222222
    v_cndmask_b32 v181, v180, v181, vcc
    v_mfma_f32_16x16x32_bf16 v[112:115], v[20:23], v[52:55], v[112:115]
    v_add_u32 v9, 7168, v11
    s_mov_b32 vcc_lo, 0x44444444
    v_mfma_f32_16x16x32_bf16 v[116:119], v[20:23], v[56:59], v[116:119]
    s_mov_b32 vcc_hi, 0x44444444
    v_cndmask_b32 v181, v181, v182, vcc
    v_mfma_f32_16x16x32_bf16 v[120:123], v[20:23], v[60:63], v[120:123]
    ds_read_b64_tr_b16 v[34:35], v14 offset:12800
    s_mov_b32 vcc_lo, 0x88888888
    v_mfma_f32_16x16x32_bf16 v[104:107], v[20:23], v[44:47], v[104:107]
    s_mov_b32 vcc_hi, 0x88888888
    v_cndmask_b32 v181, v181, v183, vcc
    v_mfma_f32_16x16x32_bf16 v[124:127], v[24:27], v[44:47], v[124:127]
    ds_read_b64_tr_b16 v[36:37], v14 offset:13312
    v_mul_f32 v184, 0xbb000000, v184
    ds_read_b64_tr_b16 v[38:39], v14 offset:13824
    v_mfma_f32_16x16x32_bf16 v[140:143], v[24:27], v[60:63], v[140:143]
    v_mul_f32 v180, v184, v184
    v_add_u32 v10, 14336, v11
    v_mfma_f32_16x16x32_bf16 v[136:139], v[24:27], v[56:59], v[136:139]
    v_mul_f32 v181, 0x3b000000, v181
    ds_read_b64_tr_b16 v[40:41], v14 offset:14336
    v_mfma_f32_16x16x32_bf16 v[132:135], v[24:27], v[52:55], v[132:135]
    v_sub_f32 v181, v181, v180
    ds_read_b64_tr_b16 v[42:43], v14 offset:14848
    v_mfma_f32_16x16x32_bf16 v[128:131], v[24:27], v[48:51], v[128:131]
    v_max_f32 v181, 0, v181
    ds_read_b128 v[88:91], v12 offset:14336
    v_mfma_f32_16x16x32_bf16 v[148:151], v[48:51], v[28:31], v[148:151]
    v_add_f32 v181, 0x3727c5ac, v181
    ds_read_b128 v[92:95], v12 offset:30720
    v_rsq_f32 v181, v181
    v_mfma_f32_16x16x32_bf16 v[152:155], v[52:55], v[28:31], v[152:155]
    v_add_u32 v18, 21504, v11
    s_lshl_b32 s46, s44, 8
    v_mfma_f32_16x16x32_bf16 v[156:159], v[56:59], v[28:31], v[156:159]
    ds_read_b128 v[96:99], v12 offset:47104
    v_add_u32 v4, s46, v4
    v_mfma_f32_16x16x32_bf16 v[160:163], v[60:63], v[28:31], v[160:163]
    ds_read_b128 v[100:103], v12 offset:63488
    ds_write2st64_b32 v4, v184, v181 offset0:1 offset1:6
    v_mfma_f32_16x16x32_bf16 v[144:147], v[44:47], v[28:31], v[144:147]
    ds_read_b128 v[84:87], v13 offset:7168
    s_waitcnt lgkmcnt(6)
    v_mfma_f32_16x16x32_bf16 v[108:111], v[32:35], v[68:71], v[108:111]
    ds_read_b64_tr_b16 v[20:21], v14 offset:24576
    ds_read_b64_tr_b16 v[22:23], v14 offset:25088
    v_mfma_f32_16x16x32_bf16 v[112:115], v[32:35], v[72:75], v[112:115]
    ds_read_b64_tr_b16 v[24:25], v14 offset:25600
    v_mfma_f32_16x16x32_bf16 v[116:119], v[32:35], v[76:79], v[116:119]
    ds_read_b64_tr_b16 v[26:27], v14 offset:26112
    v_mfma_f32_16x16x32_bf16 v[120:123], v[32:35], v[80:83], v[120:123]
    ds_read_b64_tr_b16 v[28:29], v14 offset:26624
    v_mfma_f32_16x16x32_bf16 v[104:107], v[32:35], v[64:67], v[104:107]
    ds_read_b64_tr_b16 v[30:31], v14 offset:27136
    v_mfma_f32_16x16x32_bf16 v[124:127], v[36:39], v[64:67], v[124:127]
    ds_read_b128 v[48:51], v240 offset:14336
    v_mfma_f32_16x16x32_bf16 v[140:143], v[36:39], v[80:83], v[140:143]
    ds_read_b128 v[52:55], v240 offset:30720
    v_mfma_f32_16x16x32_bf16 v[136:139], v[36:39], v[76:79], v[136:139]
    ds_read_b128 v[56:59], v240 offset:47104
    v_mfma_f32_16x16x32_bf16 v[132:135], v[36:39], v[72:75], v[132:135]
    ds_read_b128 v[60:63], v240 offset:63488
    v_mfma_f32_16x16x32_bf16 v[128:131], v[36:39], v[68:71], v[128:131]
    ds_read_b128 v[44:47], v13 offset:7232
    v_mfma_f32_16x16x32_bf16 v[148:151], v[68:71], v[40:43], v[148:151]
    ds_read_b128 v[164:167], v242
    v_mfma_f32_16x16x32_bf16 v[152:155], v[72:75], v[40:43], v[152:155]
    ds_read_b128 v[168:171], v243
    v_mfma_f32_16x16x32_bf16 v[156:159], v[76:79], v[40:43], v[156:159]
    v_mul_u32_u24 v4, 80, v2
    v_mfma_f32_16x16x32_bf16 v[160:163], v[80:83], v[40:43], v[160:163]
    v_add_u32 v4, 147456, v4
    v_mfma_f32_16x16x32_bf16 v[144:147], v[64:67], v[40:43], v[144:147]
    s_waitcnt vmcnt(3) lgkmcnt(7)
    s_barrier
    v_mfma_f32_16x16x32_bf16 v[108:111], v[20:23], v[88:91], v[108:111]
    ds_read_b64_tr_b16 v[32:33], v14 offset:36864
    ds_read_b64_tr_b16 v[34:35], v14 offset:37376
    ds_read_b64_tr_b16 v[36:37], v14 offset:37888
    v_mfma_f32_16x16x32_bf16 v[112:115], v[20:23], v[92:95], v[112:115]
    ds_read_b64_tr_b16 v[38:39], v14 offset:38400
    v_mfma_f32_16x16x32_bf16 v[116:119], v[20:23], v[96:99], v[116:119]
    ds_read_b64_tr_b16 v[40:41], v14 offset:38912
    v_mfma_f32_16x16x32_bf16 v[120:123], v[20:23], v[100:103], v[120:123]
    ds_read_b64_tr_b16 v[42:43], v14 offset:39424
    v_mfma_f32_16x16x32_bf16 v[104:107], v[20:23], v[84:87], v[104:107]
    ds_read2st64_b32 v[212:213], v5 offset0:0 offset1:5
    v_mfma_f32_16x16x32_bf16 v[124:127], v[24:27], v[84:87], v[124:127]
    ds_read2st64_b32 v[214:215], v5 offset0:1 offset1:6
    v_mfma_f32_16x16x32_bf16 v[140:143], v[24:27], v[100:103], v[140:143]
    ds_read2st64_b32 v[216:217], v5 offset0:2 offset1:7
    v_mfma_f32_16x16x32_bf16 v[136:139], v[24:27], v[96:99], v[136:139]
    ds_read2st64_b32 v[218:219], v5 offset0:3 offset1:8
    v_mfma_f32_16x16x32_bf16 v[132:135], v[24:27], v[92:95], v[132:135]
    ds_read2st64_b32 v[220:221], v5 offset0:4 offset1:9
    v_mfma_f32_16x16x32_bf16 v[128:131], v[24:27], v[88:91], v[128:131]
    ds_read_b128 v[64:67], v4 offset:0
    v_mfma_f32_16x16x32_bf16 v[148:151], v[88:91], v[28:31], v[148:151]
    ds_read_b128 v[68:71], v4 offset:256
    v_mfma_f32_16x16x32_bf16 v[152:155], v[92:95], v[28:31], v[152:155]
    ds_read_b128 v[72:75], v4 offset:512
    v_mfma_f32_16x16x32_bf16 v[156:159], v[96:99], v[28:31], v[156:159]
    ds_read_b128 v[76:79], v4 offset:768
    v_mfma_f32_16x16x32_bf16 v[160:163], v[100:103], v[28:31], v[160:163]
    ds_read_b128 v[80:83], v4 offset:1024
    v_mfma_f32_16x16x32_bf16 v[144:147], v[84:87], v[28:31], v[144:147]
    s_waitcnt lgkmcnt(10)
    v_mfma_f32_16x16x32_bf16 v[108:111], v[32:35], v[48:51], v[108:111]
    ds_read_b128 v[84:87], v4 offset:1280
    ds_read_b128 v[88:91], v4 offset:1536
    v_mfma_f32_16x16x32_bf16 v[112:115], v[32:35], v[52:55], v[112:115]
    v_mfma_f32_16x16x32_bf16 v[116:119], v[32:35], v[56:59], v[116:119]
    v_mfma_f32_16x16x32_bf16 v[120:123], v[32:35], v[60:63], v[120:123]
    ds_read_b128 v[92:95], v4 offset:1792
    v_mfma_f32_16x16x32_bf16 v[104:107], v[32:35], v[44:47], v[104:107]
    v_mfma_f32_16x16x32_bf16 v[124:127], v[36:39], v[44:47], v[124:127]
    v_mfma_f32_16x16x32_bf16 v[140:143], v[36:39], v[60:63], v[140:143]
    ds_read_b128 v[96:99], v4 offset:2048
    v_mfma_f32_16x16x32_bf16 v[136:139], v[36:39], v[56:59], v[136:139]
    v_mfma_f32_16x16x32_bf16 v[132:135], v[36:39], v[52:55], v[132:135]
    v_mfma_f32_16x16x32_bf16 v[128:131], v[36:39], v[48:51], v[128:131]
    ds_read_b128 v[100:103], v4 offset:2304
    v_mfma_f32_16x16x32_bf16 v[148:151], v[48:51], v[40:43], v[148:151]
    v_mfma_f32_16x16x32_bf16 v[152:155], v[52:55], v[40:43], v[152:155]
    v_mfma_f32_16x16x32_bf16 v[156:159], v[56:59], v[40:43], v[156:159]
    v_mfma_f32_16x16x32_bf16 v[160:163], v[60:63], v[40:43], v[160:163]
    v_mfma_f32_16x16x32_bf16 v[144:147], v[44:47], v[40:43], v[144:147]
    s_waitcnt lgkmcnt(0)
    s_barrier
    s_cmp_lt_u32 s67, 7
    s_cselect_b32 s18, s18, 0
    s_load_dword s68, s[36:37], 0
    v_mov_b32_dpp v36, v124 row_newbcast:0 row_mask:0xf bank_mask:0xf
    v_mov_b32_dpp v37, v125 row_newbcast:0 row_mask:0xf bank_mask:0xf
    v_mov_b32_dpp v38, v126 row_newbcast:0 row_mask:0xf bank_mask:0xf
    v_mov_b32_dpp v39, v127 row_newbcast:0 row_mask:0xf bank_mask:0xf
    v_mov_b32_dpp v32, v104 row_newbcast:0 row_mask:0xf bank_mask:0xf
    v_mov_b32_dpp v33, v105 row_newbcast:0 row_mask:0xf bank_mask:0xf
    v_mov_b32_dpp v34, v106 row_newbcast:0 row_mask:0xf bank_mask:0xf
    v_mov_b32_dpp v35, v107 row_newbcast:0 row_mask:0xf bank_mask:0xf
    v_pk_fma_f32 v[124:125], v[36:37], v[212:213], v[124:125] op_sel_hi:[1,0,1]
    v_pk_fma_f32 v[126:127], v[38:39], v[212:213], v[126:127] op_sel_hi:[1,0,1]
    s_add_u32 m0, s53, 0
    s_add_u32 s3, s52, 0
    buffer_load_dwordx4 v11, s[12:15], s3 offen offset:0 lds
    v_pk_fma_f32 v[128:129], v[36:37], v[214:215], v[128:129] op_sel_hi:[1,0,1]
    v_pk_fma_f32 v[130:131], v[38:39], v[214:215], v[130:131] op_sel_hi:[1,0,1]
    v_pk_fma_f32 v[132:133], v[36:37], v[216:217], v[132:133] op_sel_hi:[1,0,1]
    v_pk_fma_f32 v[134:135], v[38:39], v[216:217], v[134:135] op_sel_hi:[1,0,1]
    v_pk_fma_f32 v[136:137], v[36:37], v[218:219], v[136:137] op_sel_hi:[1,0,1]
    v_pk_fma_f32 v[138:139], v[38:39], v[218:219], v[138:139] op_sel_hi:[1,0,1]
    v_pk_fma_f32 v[140:141], v[36:37], v[220:221], v[140:141] op_sel_hi:[1,0,1]
    v_pk_fma_f32 v[142:143], v[38:39], v[220:221], v[142:143] op_sel_hi:[1,0,1]
    v_pk_fma_f32 v[108:109], v[32:33], v[214:215], v[108:109] op_sel_hi:[1,0,1]
    v_pk_fma_f32 v[110:111], v[34:35], v[214:215], v[110:111] op_sel_hi:[1,0,1]
    buffer_load_dwordx4 v9, s[12:15], s3 offen offset:1024 lds
    v_pk_fma_f32 v[112:113], v[32:33], v[216:217], v[112:113] op_sel_hi:[1,0,1]
    v_pk_fma_f32 v[114:115], v[34:35], v[216:217], v[114:115] op_sel_hi:[1,0,1]
    v_pk_fma_f32 v[116:117], v[32:33], v[218:219], v[116:117] op_sel_hi:[1,0,1]
    v_pk_fma_f32 v[118:119], v[34:35], v[218:219], v[118:119] op_sel_hi:[1,0,1]
    v_pk_fma_f32 v[120:121], v[32:33], v[220:221], v[120:121] op_sel_hi:[1,0,1]
    v_pk_fma_f32 v[122:123], v[34:35], v[220:221], v[122:123] op_sel_hi:[1,0,1]
    v_pk_mul_f32 v[124:125], v[124:125], v[212:213] op_sel:[0,1] op_sel_hi:[1,1]
    v_pk_mul_f32 v[126:127], v[126:127], v[212:213] op_sel:[0,1] op_sel_hi:[1,1]
    v_pk_mul_f32 v[128:129], v[128:129], v[214:215] op_sel:[0,1] op_sel_hi:[1,1]
    v_pk_mul_f32 v[130:131], v[130:131], v[214:215] op_sel:[0,1] op_sel_hi:[1,1]
    buffer_load_dwordx4 v10, s[12:15], s3 offen offset:2048 lds
    v_pk_mul_f32 v[132:133], v[132:133], v[216:217] op_sel:[0,1] op_sel_hi:[1,1]
    v_pk_mul_f32 v[134:135], v[134:135], v[216:217] op_sel:[0,1] op_sel_hi:[1,1]
    v_pk_mul_f32 v[136:137], v[136:137], v[218:219] op_sel:[0,1] op_sel_hi:[1,1]
    v_pk_mul_f32 v[138:139], v[138:139], v[218:219] op_sel:[0,1] op_sel_hi:[1,1]
    v_pk_mul_f32 v[140:141], v[140:141], v[220:221] op_sel:[0,1] op_sel_hi:[1,1]
    v_pk_mul_f32 v[142:143], v[142:143], v[220:221] op_sel:[0,1] op_sel_hi:[1,1]
    v_cvt_pk_bf16_f32 v230, v124, v125
    v_cvt_pk_bf16_f32 v231, v126, v127
    v_cvt_pk_bf16_f32 v232, v128, v129
    v_cvt_pk_bf16_f32 v233, v130, v131
    buffer_load_dwordx4 v18, s[12:15], s3 offen offset:3072 lds
    v_cvt_pk_bf16_f32 v234, v132, v133
    v_cvt_pk_bf16_f32 v235, v134, v135
    v_cvt_pk_bf16_f32 v236, v136, v137
    v_cvt_pk_bf16_f32 v237, v138, v139
    v_cvt_pk_bf16_f32 v238, v140, v141
    v_cvt_pk_bf16_f32 v239, v142, v143
    v_cvt_pk_bf16_f32 v222, v108, v109
    v_cvt_pk_bf16_f32 v223, v110, v111
    v_cvt_pk_bf16_f32 v224, v112, v113
    v_cvt_pk_bf16_f32 v225, v114, v115
    s_add_u32 m0, s53, 16384
    s_add_u32 s3, s52, 131072
    buffer_load_dwordx4 v11, s[12:15], s3 offen offset:0 lds
    v_cvt_pk_bf16_f32 v226, v116, v117
    v_cvt_pk_bf16_f32 v227, v118, v119
    v_cvt_pk_bf16_f32 v228, v120, v121
    v_cvt_pk_bf16_f32 v229, v122, v123
    v_mov_b32 v40, v144
    v_mov_b32 v41, v144
    v_mfma_f32_16x16x16_bf16 v[44:47], v[232:233], v[222:223], v[192:195]
    s_nop 0
    v_permlane16_swap_b32 v40, v41
    s_mov_b32 s46, 0x3eb8aa3b
    v_mfma_f32_16x16x16_bf16 v[172:175], v[230:231], v[222:223], v[200:203]
    v_mul_f32 v215, s46, v215
    buffer_load_dwordx4 v9, s[12:15], s3 offen offset:1024 lds
    v_mul_f32 v217, s46, v217
    v_mfma_f32_16x16x16_bf16 v[48:51], v[234:235], v[224:225], v[192:195]
    v_mul_f32 v219, s46, v219
    v_mul_f32 v221, s46, v221
    v_mfma_f32_16x16x16_bf16 v[176:179], v[232:233], v[224:225], v[196:199]
    v_pk_fma_f32 v[144:145], v[64:65], v[40:41], v[144:145] op_sel_hi:[1,0,1]
    v_pk_fma_f32 v[146:147], v[66:67], v[40:41], v[146:147] op_sel_hi:[1,0,1]
    v_mfma_f32_16x16x16_bf16 v[52:55], v[236:237], v[226:227], v[192:195]
    v_pk_fma_f32 v[148:149], v[68:69], v[40:41], v[148:149] op_sel_hi:[1,0,1]
    v_pk_fma_f32 v[150:151], v[70:71], v[40:41], v[150:151] op_sel_hi:[1,0,1]
    buffer_load_dwordx4 v10, s[12:15], s3 offen offset:2048 lds
    v_mfma_f32_16x16x16_bf16 v[180:183], v[234:235], v[226:227], v[196:199]
    v_pk_fma_f32 v[152:153], v[72:73], v[40:41], v[152:153] op_sel_hi:[1,0,1]
    v_pk_fma_f32 v[154:155], v[74:75], v[40:41], v[154:155] op_sel_hi:[1,0,1]
    v_mfma_f32_16x16x16_bf16 v[56:59], v[238:239], v[228:229], v[192:195]
    v_pk_fma_f32 v[156:157], v[76:77], v[40:41], v[156:157] op_sel_hi:[1,0,1]
    v_pk_fma_f32 v[158:159], v[78:79], v[40:41], v[158:159] op_sel_hi:[1,0,1]
    v_mfma_f32_16x16x16_bf16 v[184:187], v[236:237], v[228:229], v[196:199]
    v_pk_fma_f32 v[160:161], v[80:81], v[40:41], v[160:161] op_sel_hi:[1,0,1]
    v_pk_fma_f32 v[162:163], v[82:83], v[40:41], v[162:163] op_sel_hi:[1,0,1]
    v_pk_mul_f32 v[144:145], v[144:145], v[84:85]
    buffer_load_dwordx4 v18, s[12:15], s3 offen offset:3072 lds
    v_pk_mul_f32 v[146:147], v[146:147], v[86:87]
    v_pk_mul_f32 v[148:149], v[148:149], v[88:89]
    v_pk_mul_f32 v[150:151], v[150:151], v[90:91]
    v_pk_mul_f32 v[152:153], v[152:153], v[92:93]
    v_pk_mul_f32 v[154:155], v[154:155], v[94:95]
    v_max_f32 v44, v44, v172
    v_max_f32 v45, v45, v173
    v_max_f32 v46, v46, v174
    v_max_f32 v47, v47, v175
    v_max_f32 v48, v48, v176
    s_add_u32 m0, s53, 32768
    s_add_u32 s3, s52, 262144
    buffer_load_dwordx4 v11, s[12:15], s3 offen offset:0 lds
    v_max_f32 v49, v49, v177
    v_max_f32 v50, v50, v178
    v_max_f32 v51, v51, v179
    v_max_f32 v52, v52, v180
    v_max_f32 v53, v53, v181
    v_max_f32 v54, v54, v182
    v_max_f32 v55, v55, v183
    v_max_f32 v56, v56, v184
    v_max_f32 v57, v57, v185
    v_max_f32 v58, v58, v186
    buffer_load_dwordx4 v9, s[12:15], s3 offen offset:1024 lds
    v_max_f32 v59, v59, v187
    v_max3_f32 v104, v44, v45, v46
    v_max3_f32 v105, v48, v49, v50
    v_max3_f32 v106, v52, v53, v54
    v_max3_f32 v107, v56, v57, v58
    v_max_f32 v104, v104, v47
    v_max_f32 v105, v105, v51
    v_max_f32 v106, v106, v55
    v_max_f32 v107, v107, v59
    v_pk_mul_f32 v[156:157], v[156:157], v[96:97]
    buffer_load_dwordx4 v10, s[12:15], s3 offen offset:2048 lds
    v_pk_mul_f32 v[158:159], v[158:159], v[98:99]
    v_permlane16_swap_b32 v104, v105
    v_permlane16_swap_b32 v106, v107
    v_pk_mul_f32 v[160:161], v[160:161], v[100:101]
    v_pk_mul_f32 v[162:163], v[162:163], v[102:103]
    v_max_f32 v104, v104, v105
    v_max_f32 v106, v106, v107
    v_cvt_pk_bf16_f32 v20, v144, v145
    v_cvt_pk_bf16_f32 v21, v146, v147
    v_permlane32_swap_b32 v104, v106
    buffer_load_dwordx4 v18, s[12:15], s3 offen offset:3072 lds
    v_cvt_pk_bf16_f32 v22, v148, v149
    v_cvt_pk_bf16_f32 v23, v150, v151
    v_max_f32 v105, v104, v106
    v_max_f32 v107, v104, v106
    v_cvt_pk_bf16_f32 v24, v152, v153
    s_nop 0
    v_permlane32_swap_b32 v105, v107
    v_cvt_pk_bf16_f32 v25, v154, v155
    v_cvt_pk_bf16_f32 v26, v156, v157
    v_mov_b32 v104, v105
    v_mov_b32 v106, v107
    s_add_u32 m0, s53, 49152
    s_add_u32 s3, s52, 393216
    buffer_load_dwordx4 v11, s[12:15], s3 offen offset:0 lds
    v_cvt_pk_bf16_f32 v27, v158, v159
    v_cvt_pk_bf16_f32 v28, v160, v161
    v_permlane16_swap_b32 v104, v105
    v_permlane16_swap_b32 v106, v107
    v_cvt_pk_bf16_f32 v29, v162, v163
    v_mul_f32 v104, v215, v104
    v_mul_f32 v105, v217, v105
    v_mul_f32 v106, v219, v106
    v_mul_f32 v107, v221, v107
    v_pk_fma_f32 v[44:45], v[44:45], v[214:215], v[104:105] op_sel:[0,1,0] op_sel_hi:[1,1,0] neg_lo:[0,0,1] neg_hi:[0,0,1]
    buffer_load_dwordx4 v9, s[12:15], s3 offen offset:1024 lds
    v_pk_fma_f32 v[46:47], v[46:47], v[214:215], v[104:105] op_sel:[0,1,0] op_sel_hi:[1,1,0] neg_lo:[0,0,1] neg_hi:[0,0,1]
    v_pk_fma_f32 v[48:49], v[48:49], v[216:217], v[104:105] op_sel:[0,1,1] op_sel_hi:[1,1,1] neg_lo:[0,0,1] neg_hi:[0,0,1]
    v_pk_fma_f32 v[50:51], v[50:51], v[216:217], v[104:105] op_sel:[0,1,1] op_sel_hi:[1,1,1] neg_lo:[0,0,1] neg_hi:[0,0,1]
    v_pk_fma_f32 v[52:53], v[52:53], v[218:219], v[106:107] op_sel:[0,1,0] op_sel_hi:[1,1,0] neg_lo:[0,0,1] neg_hi:[0,0,1]
    v_pk_fma_f32 v[54:55], v[54:55], v[218:219], v[106:107] op_sel:[0,1,0] op_sel_hi:[1,1,0] neg_lo:[0,0,1] neg_hi:[0,0,1]
    v_pk_fma_f32 v[56:57], v[56:57], v[220:221], v[106:107] op_sel:[0,1,1] op_sel_hi:[1,1,1] neg_lo:[0,0,1] neg_hi:[0,0,1]
    v_pk_fma_f32 v[58:59], v[58:59], v[220:221], v[106:107] op_sel:[0,1,1] op_sel_hi:[1,1,1] neg_lo:[0,0,1] neg_hi:[0,0,1]
    v_exp_f32 v44, v44
    v_exp_f32 v45, v45
    v_exp_f32 v46, v46
    buffer_load_dwordx4 v10, s[12:15], s3 offen offset:2048 lds
    v_exp_f32 v47, v47
    v_exp_f32 v48, v48
    v_exp_f32 v49, v49
    v_exp_f32 v50, v50
    v_exp_f32 v51, v51
    v_exp_f32 v52, v52
    v_exp_f32 v53, v53
    v_exp_f32 v54, v54
    v_exp_f32 v55, v55
    v_exp_f32 v56, v56
    buffer_load_dwordx4 v18, s[12:15], s3 offen offset:3072 lds
    v_exp_f32 v57, v57
    v_exp_f32 v58, v58
    v_exp_f32 v59, v59
    v_cvt_pk_bf16_f32 v112, v44, v45
    v_cvt_pk_bf16_f32 v113, v46, v47
    v_and_b32 v124, v112, v206
    v_and_b32 v126, v112, v204
    v_and_b32 v125, v113, v207
    v_and_b32 v127, v113, v205
    v_cvt_pk_bf16_f32 v114, v48, v49
    s_mul_i32 s3, s66, 0
    s_cmp_gt_u32 s65, 0
    s_cselect_b32 m0, s60, s61
    s_add_u32 s3, s3, m0
    s_add_u32 m0, s64, 0
    s_nop 0
    buffer_load_dwordx4 v244, s[16:19], s3 offen lds
    v_cvt_pk_bf16_f32 v115, v50, v51
    v_and_b32 v128, v114, v206
    v_and_b32 v130, v114, v204
    v_and_b32 v129, v115, v207
    v_and_b32 v131, v115, v205
    v_cvt_pk_bf16_f32 v116, v52, v53
    v_cvt_pk_bf16_f32 v117, v54, v55
    v_and_b32 v132, v116, v206
    v_and_b32 v134, v116, v204
    v_and_b32 v133, v117, v207
    buffer_load_dwordx4 v245, s[16:19], s3 offen offset:1024 lds
    v_and_b32 v135, v117, v205
    v_cvt_pk_bf16_f32 v118, v56, v57
    v_cvt_pk_bf16_f32 v119, v58, v59
    v_and_b32 v136, v118, v206
    v_and_b32 v138, v118, v204
    v_and_b32 v137, v119, v207
    v_and_b32 v139, v119, v205
    v_mfma_f32_16x16x16_bf16 v[172:175], v[208:209], v[112:113], 0
    s_lshl2_add_u32 s46, s55, s44
    s_lshl_b32 s48, s54, 7
    v_mfma_f32_16x16x16_bf16 v[176:179], v[208:209], v[114:115], 0
    s_add_u32 s48, s48, s55
    s_lshl_b32 s48, s48, 2
    v_mfma_f32_16x16x16_bf16 v[180:183], v[208:209], v[116:117], 0
    buffer_load_dwordx4 v246, s[16:19], s3 offen offset:2048 lds
    s_add_u32 s48, s48, 0x840000
    v_mfma_f32_16x16x16_bf16 v[184:187], v[208:209], v[118:119], 0
    s_lshl_b32 s46, s46, 9
    s_lshl_b32 s47, s54, 16
    v_mfma_f32_16x16x32_bf16 v[44:47], v[20:23], v[124:127], 0
    s_add_u32 s46, s46, s47
    s_add_u32 s47, s46, 32768
    v_mfma_f32_16x16x32_bf16 v[48:51], v[22:25], v[128:131], 0
    v_lshrrev_b32 v7, 2, v1
    v_mfma_f32_16x16x32_bf16 v[52:55], v[24:27], v[132:135], 0
    v_and_b32 v5, 3, v1
    v_lshlrev_b32 v5, 7, v5
    v_mfma_f32_16x16x32_bf16 v[56:59], v[26:29], v[136:139], 0
    v_lshl_add_u32 v7, v7, 14, v5
    s_waitcnt lgkmcnt(0)
    s_cmp_lg_u32 s68, 0
    s_cbranch_scc0 L_non
L_nonok:
    s_mov_b32 s69, s68
    v_mov_b32 v6, s68
    buffer_load_dwordx4 v247, s[16:19], s3 offen offset:3072 lds
    v_rcp_f32 v172, v172
    v_rcp_f32 v176, v176
    v_rcp_f32 v180, v180
    v_rcp_f32 v184, v184
    v_pk_mul_f32 v[44:45], v[44:45], v[172:173] op_sel_hi:[1,0]
    v_pk_mul_f32 v[46:47], v[46:47], v[172:173] op_sel_hi:[1,0]
    v_pk_mul_f32 v[48:49], v[48:49], v[176:177] op_sel_hi:[1,0]
    v_pk_mul_f32 v[50:51], v[50:51], v[176:177] op_sel_hi:[1,0]
    v_pk_mul_f32 v[52:53], v[52:53], v[180:181] op_sel_hi:[1,0]
    v_pk_mul_f32 v[54:55], v[54:55], v[180:181] op_sel_hi:[1,0]
    v_pk_mul_f32 v[56:57], v[56:57], v[184:185] op_sel_hi:[1,0]
    v_pk_mul_f32 v[58:59], v[58:59], v[184:185] op_sel_hi:[1,0]
    v_cvt_pk_bf16_f32 v140, v44, v45
    v_cvt_pk_bf16_f32 v141, v46, v47
    v_cvt_pk_bf16_f32 v142, v48, v49
    v_cvt_pk_bf16_f32 v143, v50, v51
    v_cvt_pk_bf16_f32 v144, v52, v53
    v_cvt_pk_bf16_f32 v145, v54, v55
    v_cvt_pk_bf16_f32 v146, v56, v57
    v_cvt_pk_bf16_f32 v147, v58, v59
    v_permlane32_swap_b32 v140, v142
    v_permlane32_swap_b32 v141, v143
    v_permlane32_swap_b32 v144, v146
    v_permlane32_swap_b32 v145, v147
    buffer_store_dwordx4 v[140:143], v253, s[40:43], s46 offen sc1
    buffer_store_dwordx4 v[144:147], v253, s[40:43], s47 offen sc1
    s_waitcnt vmcnt(6)
    s_barrier
    s_cmp_lg_u32 s44, 0
    s_cbranch_scc1 L_nf1
    s_mov_b32 exec_hi, 0
    buffer_store_dword v6, v7, s[40:43], s48 offen sc1
    s_mov_b32 exec_hi, -1
L_nf1:
    s_mul_i32 s59, s100, 7
    s_mul_i32 s3, s66, 1
    s_cmp_gt_u32 s65, 1
    s_cselect_b32 m0, s60, s61
    s_add_u32 s3, s3, m0
    s_add_u32 m0, s64, 4096
    s_nop 0
    buffer_load_dwordx4 v244, s[16:19], s3 offen lds
    s_lshr_b32 s59, s59, 2
    s_and_b32 s59, s59, 14
    s_mul_i32 s46, s44, 14
    s_add_u32 s46, s46, s59
    s_lshl_b32 s62, s46, 17
    s_lshl_b32 s46, s57, 7
    buffer_load_dwordx4 v245, s[16:19], s3 offen offset:1024 lds
    s_add_u32 s62, s62, s46
    s_sub_u32 s63, s62, 1835008
    s_lshl_b32 s52, s44, 12
    v_bfe_u32 v241, v1, 3, 2
    v_lshrrev_b32 v240, 5, v1
    v_lshl_add_u32 v240, v240, 4, v241
    v_lshlrev_b32 v240, 12, v240
    buffer_load_dwordx4 v246, s[16:19], s3 offen offset:2048 lds
    v_lshrrev_b32 v241, 1, v1
    v_and_b32 v242, 1, v2
    v_xor_b32 v241, v241, v242
    v_and_b32 v241, 3, v241
    v_lshl_add_u32 v240, v241, 5, v240
    v_and_b32 v241, 1, v1
    buffer_load_dwordx4 v247, s[16:19], s3 offen offset:3072 lds
    v_lshl_add_u32 v240, v241, 4, v240
    v_xor_b32 v241, 64, v240
    v_add_u32 v242, 30720, v240
    v_add_u32 v243, 46080, v241
    v_add_u32 v241, 15360, v241
    v_bfe_u32 v29, v1, 2, 2
    v_lshl_add_u32 v29, v2, 3, v29
    s_mov_b32 s49, s44
    v_lshlrev_b32 v28, 7, v29
    v_bfe_u32 v29, v1, 3, 2
    v_xor_b32 v29, s49, v29
    v_lshl_add_u32 v28, v29, 5, v28
    v_and_b32 v29, 3, v1
    v_lshl_add_u32 v28, v29, 3, v28
    v_add_u32 v28, s64, v28
    v_xor_b32 v29, 32, v28
    v_xor_b32 v30, 64, v28
    v_xor_b32 v31, 96, v28
    v_bfe_u32 v4, v1, 2, 3
    v_lshrrev_b32 v5, 5, v1
    v_lshl_add_u32 v4, v5, 4, v4
    v_lshlrev_b32 v12, 7, v4
    v_bfe_u32 v4, v1, 3, 2
    v_lshl_add_u32 v12, v4, 5, v12
    v_and_b32 v4, 3, v1
    v_lshl_add_u32 v12, v4, 3, v12
    v_xor_b32 v13, 32, v12
    v_xor_b32 v14, 64, v12
    v_xor_b32 v15, 96, v12
    v_and_b32 v4, 1, v3
    v_lshlrev_b32 v4, 4, v4
    v_mov_b32 v5, 0x3f80
    v_lshlrev_b32 v4, v4, v5
    v_lshrrev_b32 v5, 1, v3
    v_lshlrev_b32 v19, 2, v2
    v_sub_u32 v5, v5, v19
    v_cmp_eq_i32 vcc, 0, v5
    s_nop 1
    v_cndmask_b32 v20, 0, v4, vcc
    v_cmp_eq_i32 vcc, 1, v5
    s_nop 1
    v_cndmask_b32 v21, 0, v4, vcc
    v_cmp_eq_i32 vcc, 2, v5
    s_nop 1
    v_cndmask_b32 v22, 0, v4, vcc
    v_cmp_eq_i32 vcc, 3, v5
    s_nop 1
    v_cndmask_b32 v23, 0, v4, vcc
    v_cmp_eq_i32 vcc, -8, v5
    s_nop 1
    v_cndmask_b32 v24, 0, v4, vcc
    v_cmp_eq_i32 vcc, -7, v5
    s_nop 1
    v_cndmask_b32 v25, 0, v4, vcc
    v_cmp_eq_i32 vcc, -6, v5
    s_nop 1
    v_cndmask_b32 v26, 0, v4, vcc
    v_cmp_eq_i32 vcc, -5, v5
    s_nop 1
    v_cndmask_b32 v27, 0, v4, vcc
    v_and_b32 v4, 1, v2
    v_lshlrev_b32 v9, 10, v4
    v_lshrrev_b32 v4, 1, v2
    v_lshl_add_u32 v9, v4, 8, v9
    v_lshl_add_u32 v9, v3, 4, v9
    v_lshrrev_b32 v4, 2, v3
    v_lshlrev_b32 v10, 8, v4
    v_lshl_add_u32 v10, v2, 6, v10
    v_and_b32 v4, 3, v3
    v_lshl_add_u32 v10, v4, 4, v10
    v_mfma_f32_16x16x32_bf16 v[128:131], v[164:167], v[20:23], 0
    v_mfma_f32_16x16x32_bf16 v[132:135], v[164:167], v[24:27], 0
    v_mfma_f32_16x16x32_bf16 v[136:139], v[168:171], v[20:23], 0
    v_mfma_f32_16x16x32_bf16 v[140:143], v[168:171], v[24:27], 0
    s_lshl_b32 s53, s55, 5
    s_add_u32 s53, s53, s54
    s_lshl2_add_u32 s53, s53, s44
    s_lshl_b32 s53, s53, 7
    s_add_u32 s53, s53, 0x840000
    v_lshlrev_b32 v7, 9, v1
    s_lshl2_add_u32 s50, s54, s44
    s_lshl_b32 s47, s50, 14
    ds_read_b64_tr_b16 v[32:33], v12 offset:0
    ds_read_b64_tr_b16 v[34:35], v12 offset:1024
    ds_read_b64_tr_b16 v[36:37], v13 offset:0
    ds_read_b64_tr_b16 v[38:39], v13 offset:1024
    ds_read_b64_tr_b16 v[40:41], v14 offset:0
    ds_read_b64_tr_b16 v[42:43], v14 offset:1024
    ds_read_b64_tr_b16 v[44:45], v15 offset:0
    ds_read_b64_tr_b16 v[46:47], v15 offset:1024
    ds_read_b64_tr_b16 v[48:49], v12 offset:4096
    ds_read_b64_tr_b16 v[50:51], v12 offset:5120
    ds_read_b64_tr_b16 v[52:53], v13 offset:4096
    ds_read_b64_tr_b16 v[54:55], v13 offset:5120
    ds_read_b64_tr_b16 v[56:57], v14 offset:4096
    ds_read_b64_tr_b16 v[58:59], v14 offset:5120
    ds_read_b64_tr_b16 v[60:61], v15 offset:4096
    ds_read_b64_tr_b16 v[62:63], v15 offset:5120
    ds_read_b64_tr_b16 v[176:177], v12 offset:8192
    ds_read_b64_tr_b16 v[178:179], v12 offset:9216
    ds_read_b64_tr_b16 v[180:181], v13 offset:8192
    ds_read_b64_tr_b16 v[182:183], v13 offset:9216
    ds_read_b64_tr_b16 v[184:185], v14 offset:8192
    ds_read_b64_tr_b16 v[186:187], v14 offset:9216
    ds_read_b64_tr_b16 v[188:189], v15 offset:8192
    ds_read_b64_tr_b16 v[190:191], v15 offset:9216
    ds_read_b64_tr_b16 v[192:193], v12 offset:12288
    ds_read_b64_tr_b16 v[194:195], v12 offset:13312
    ds_read_b64_tr_b16 v[196:197], v13 offset:12288
    ds_read_b64_tr_b16 v[198:199], v13 offset:13312
    ds_read_b64_tr_b16 v[200:201], v14 offset:12288
    ds_read_b64_tr_b16 v[202:203], v14 offset:13312
    ds_read_b64_tr_b16 v[204:205], v15 offset:12288
    ds_read_b64_tr_b16 v[206:207], v15 offset:13312
    ds_read_b64_tr_b16 v[208:209], v12 offset:16384
    ds_read_b64_tr_b16 v[210:211], v12 offset:17408
    ds_read_b64_tr_b16 v[212:213], v13 offset:16384
    ds_read_b64_tr_b16 v[214:215], v13 offset:17408
    ds_read_b64_tr_b16 v[216:217], v14 offset:16384
    ds_read_b64_tr_b16 v[218:219], v14 offset:17408
    ds_read_b64_tr_b16 v[220:221], v15 offset:16384
    ds_read_b64_tr_b16 v[222:223], v15 offset:17408
    s_mul_i32 s3, s66, 2
    s_cmp_gt_u32 s65, 2
    s_cselect_b32 m0, s60, s61
    s_add_u32 s3, s3, m0
    s_add_u32 m0, s64, 8192
    s_nop 0
    buffer_load_dwordx4 v244, s[16:19], s3 offen lds
    buffer_load_dwordx4 v245, s[16:19], s3 offen offset:1024 lds
    buffer_load_dwordx4 v246, s[16:19], s3 offen offset:2048 lds
    buffer_load_dwordx4 v247, s[16:19], s3 offen offset:3072 lds
    ds_read_b64_tr_b16 v[224:225], v12 offset:20480
    ds_read_b64_tr_b16 v[226:227], v12 offset:21504
    ds_read_b64_tr_b16 v[228:229], v13 offset:20480
    ds_read_b64_tr_b16 v[230:231], v13 offset:21504
    ds_read_b64_tr_b16 v[232:233], v14 offset:20480
    ds_read_b64_tr_b16 v[234:235], v14 offset:21504
    ds_read_b64_tr_b16 v[236:237], v15 offset:20480
    ds_read_b64_tr_b16 v[238:239], v15 offset:21504
    ds_read_b64_tr_b16 a[96:97], v12 offset:24576
    ds_read_b64_tr_b16 a[98:99], v12 offset:25600
    ds_read_b64_tr_b16 a[100:101], v13 offset:24576
    ds_read_b64_tr_b16 a[102:103], v13 offset:25600
    ds_read_b64_tr_b16 a[104:105], v14 offset:24576
    ds_read_b64_tr_b16 a[106:107], v14 offset:25600
    ds_read_b64_tr_b16 a[108:109], v15 offset:24576
    ds_read_b64_tr_b16 a[110:111], v15 offset:25600
    ds_read_b64_tr_b16 a[112:113], v12 offset:28672
    ds_read_b64_tr_b16 a[114:115], v12 offset:29696
    ds_read_b64_tr_b16 a[116:117], v13 offset:28672
    ds_read_b64_tr_b16 a[118:119], v13 offset:29696
    ds_read_b64_tr_b16 a[120:121], v14 offset:28672
    ds_read_b64_tr_b16 a[122:123], v14 offset:29696
    ds_read_b64_tr_b16 a[124:125], v15 offset:28672
    ds_read_b64_tr_b16 a[126:127], v15 offset:29696
L_p1:
    s_load_dwordx8 s[4:11], s[40:41], s53 glc
    s_waitcnt lgkmcnt(0)
    s_xor_b64 s[4:5], s[4:5], s[68:69]
    s_xor_b64 s[6:7], s[6:7], s[68:69]
    s_xor_b64 s[8:9], s[8:9], s[68:69]
    s_xor_b64 s[10:11], s[10:11], s[68:69]
    s_or_b64 s[4:5], s[4:5], s[6:7]
    s_or_b64 s[8:9], s[8:9], s[10:11]
    s_or_b64 s[4:5], s[4:5], s[8:9]
    s_cbranch_scc0 L_p1_ok
    s_sub_u32 s45, s45, 1
    s_cbranch_scc0 L_p1
    s_mov_b32 s45, 0
L_p1_ok:
    s_mov_b32 s51, s47
    buffer_load_dwordx4 v[64:67], v0, s[40:43], s47 offen offset:0 sc1
    buffer_load_dwordx4 v[68:71], v0, s[40:43], s47 offen offset:1024 sc1
    buffer_load_dwordx4 v[72:75], v0, s[40:43], s47 offen offset:2048 sc1
    buffer_load_dwordx4 v[76:79], v0, s[40:43], s47 offen offset:3072 sc1
    s_add_u32 s47, s47, 4096
    buffer_load_dwordx4 v[80:83], v0, s[40:43], s47 offen offset:0 sc1
    buffer_load_dwordx4 v[84:87], v0, s[40:43], s47 offen offset:1024 sc1
    buffer_load_dwordx4 v[88:91], v0, s[40:43], s47 offen offset:2048 sc1
    buffer_load_dwordx4 v[92:95], v0, s[40:43], s47 offen offset:3072 sc1
    s_add_u32 s47, s47, 4096
    buffer_load_dwordx4 v[96:99], v0, s[40:43], s47 offen offset:0 sc1
    buffer_load_dwordx4 v[100:103], v0, s[40:43], s47 offen offset:1024 sc1
    buffer_load_dwordx4 v[104:107], v0, s[40:43], s47 offen offset:2048 sc1
    buffer_load_dwordx4 v[108:111], v0, s[40:43], s47 offen offset:3072 sc1
    s_add_u32 s47, s47, 4096
    buffer_load_dwordx4 v[112:115], v0, s[40:43], s47 offen offset:0 sc1
    buffer_load_dwordx4 v[116:119], v0, s[40:43], s47 offen offset:1024 sc1
    buffer_load_dwordx4 v[120:123], v0, s[40:43], s47 offen offset:2048 sc1
    buffer_load_dwordx4 v[124:127], v0, s[40:43], s47 offen offset:3072 sc1
    s_lshl_b32 s46, s55, 18
    s_lshr_b32 s3, s50, 1
    s_lshl_b32 s3, s3, 12
    s_add_u32 s46, s46, s3
    s_and_b32 s3, s50, 1
    s_lshl_b32 s3, s3, 9
    s_add_u32 s46, s46, s3
    s_add_u32 s46, s46, 0x400000
    s_lshl_b32 s47, s50, 11
    s_add_u32 s47, s47, 0x800000
    s_lshl_b32 s48, s55, 8
    s_add_u32 s48, s48, s47
    v_lshlrev_b32 v4, 2, v1
    ds_read_b64_tr_b16 a[128:129], v12 offset:32768
    s_mul_i32 s3, s66, 3
    s_cmp_gt_u32 s65, 3
    s_cselect_b32 m0, s60, s61
    s_add_u32 s3, s3, m0
    s_add_u32 m0, s64, 12288
    s_nop 0
    buffer_load_dwordx4 v244, s[16:19], s3 offen lds
    ds_read_b64_tr_b16 a[130:131], v12 offset:33792
    ds_read_b64_tr_b16 a[132:133], v13 offset:32768
    ds_read_b64_tr_b16 a[134:135], v13 offset:33792
    ds_read_b64_tr_b16 a[136:137], v14 offset:32768
    ds_read_b64_tr_b16 a[138:139], v14 offset:33792
    ds_read_b64_tr_b16 a[140:141], v15 offset:32768
    ds_read_b64_tr_b16 a[142:143], v15 offset:33792
    ds_read_b64_tr_b16 a[144:145], v12 offset:36864
    buffer_load_dwordx4 v245, s[16:19], s3 offen offset:1024 lds
    ds_read_b64_tr_b16 a[146:147], v12 offset:37888
    ds_read_b64_tr_b16 a[148:149], v13 offset:36864
    ds_read_b64_tr_b16 a[150:151], v13 offset:37888
    ds_read_b64_tr_b16 a[152:153], v14 offset:36864
    ds_read_b64_tr_b16 a[154:155], v14 offset:37888
    ds_read_b64_tr_b16 a[156:157], v15 offset:36864
    ds_read_b64_tr_b16 a[158:159], v15 offset:37888
    ds_read_b64_tr_b16 a[160:161], v12 offset:40960
    buffer_load_dwordx4 v246, s[16:19], s3 offen offset:2048 lds
    ds_read_b64_tr_b16 a[162:163], v12 offset:41984
    ds_read_b64_tr_b16 a[164:165], v13 offset:40960
    ds_read_b64_tr_b16 a[166:167], v13 offset:41984
    ds_read_b64_tr_b16 a[168:169], v14 offset:40960
    ds_read_b64_tr_b16 a[170:171], v14 offset:41984
    ds_read_b64_tr_b16 a[172:173], v15 offset:40960
    ds_read_b64_tr_b16 a[174:175], v15 offset:41984
    ds_read_b64_tr_b16 a[176:177], v12 offset:45056
    buffer_load_dwordx4 v247, s[16:19], s3 offen offset:3072 lds
    ds_read_b64_tr_b16 a[178:179], v12 offset:46080
    ds_read_b64_tr_b16 a[180:181], v13 offset:45056
    ds_read_b64_tr_b16 a[182:183], v13 offset:46080
    ds_read_b64_tr_b16 a[184:185], v14 offset:45056
    ds_read_b64_tr_b16 a[186:187], v14 offset:46080
    ds_read_b64_tr_b16 a[188:189], v15 offset:45056
    ds_read_b64_tr_b16 a[190:191], v15 offset:46080
    s_waitcnt vmcnt(16)
    v_max3_u32 v253, v64, v68, v72
    v_max_u32 v253, v253, v76
    v_cmp_eq_u32 vcc, -1, v253
    s_cbranch_vccnz L_ro0
L_ro0_b:
    v_mfma_f32_16x16x32_bf16 v[128:131], v[64:67], v[32:35], v[128:131]
    ds_read_b64_tr_b16 a[192:193], v12 offset:49152
    s_mul_i32 s3, s66, 4
    s_cmp_gt_u32 s65, 4
    s_cselect_b32 m0, s60, s61
    s_add_u32 s3, s3, m0
    s_add_u32 m0, s64, 16384
    s_nop 0
    buffer_load_dwordx4 v244, s[16:19], s3 offen lds
    ds_read_b64_tr_b16 a[194:195], v12 offset:50176
    v_mfma_f32_16x16x32_bf16 v[132:135], v[64:67], v[36:39], v[132:135]
    ds_read_b64_tr_b16 a[196:197], v13 offset:49152
    ds_read_b64_tr_b16 a[198:199], v13 offset:50176
    v_mfma_f32_16x16x32_bf16 v[136:139], v[64:67], v[40:43], v[136:139]
    ds_read_b64_tr_b16 a[200:201], v14 offset:49152
    ds_read_b64_tr_b16 a[202:203], v14 offset:50176
    v_mfma_f32_16x16x32_bf16 v[140:143], v[64:67], v[44:47], v[140:143]
    ds_read_b64_tr_b16 a[204:205], v15 offset:49152
    ds_read_b64_tr_b16 a[206:207], v15 offset:50176
    v_mfma_f32_16x16x32_bf16 v[128:131], v[68:71], v[48:51], v[128:131]
    ds_read_b64_tr_b16 a[208:209], v12 offset:53248
    buffer_load_dwordx4 v245, s[16:19], s3 offen offset:1024 lds
    ds_read_b64_tr_b16 a[210:211], v12 offset:54272
    v_mfma_f32_16x16x32_bf16 v[132:135], v[68:71], v[52:55], v[132:135]
    ds_read_b64_tr_b16 a[212:213], v13 offset:53248
    ds_read_b64_tr_b16 a[214:215], v13 offset:54272
    v_mfma_f32_16x16x32_bf16 v[136:139], v[68:71], v[56:59], v[136:139]
    ds_read_b64_tr_b16 a[216:217], v14 offset:53248
    ds_read_b64_tr_b16 a[218:219], v14 offset:54272
    v_mfma_f32_16x16x32_bf16 v[140:143], v[68:71], v[60:63], v[140:143]
    ds_read_b64_tr_b16 a[220:221], v15 offset:53248
    ds_read_b64_tr_b16 a[222:223], v15 offset:54272
    v_mfma_f32_16x16x32_bf16 v[128:131], v[72:75], v[176:179], v[128:131]
    ds_read_b64_tr_b16 a[224:225], v12 offset:57344
    buffer_load_dwordx4 v246, s[16:19], s3 offen offset:2048 lds
    ds_read_b64_tr_b16 a[226:227], v12 offset:58368
    v_mfma_f32_16x16x32_bf16 v[132:135], v[72:75], v[180:183], v[132:135]
    ds_read_b64_tr_b16 a[228:229], v13 offset:57344
    ds_read_b64_tr_b16 a[230:231], v13 offset:58368
    v_mfma_f32_16x16x32_bf16 v[136:139], v[72:75], v[184:187], v[136:139]
    ds_read_b64_tr_b16 a[232:233], v14 offset:57344
    ds_read_b64_tr_b16 a[234:235], v14 offset:58368
    v_mfma_f32_16x16x32_bf16 v[140:143], v[72:75], v[188:191], v[140:143]
    ds_read_b64_tr_b16 a[236:237], v15 offset:57344
    ds_read_b64_tr_b16 a[238:239], v15 offset:58368
    v_mfma_f32_16x16x32_bf16 v[128:131], v[76:79], v[192:195], v[128:131]
    ds_read_b64_tr_b16 a[240:241], v12 offset:61440
    buffer_load_dwordx4 v247, s[16:19], s3 offen offset:3072 lds
    ds_read_b64_tr_b16 a[242:243], v12 offset:62464
    ds_read_b64_tr_b16 a[244:245], v13 offset:61440
    v_mfma_f32_16x16x32_bf16 v[132:135], v[76:79], v[196:199], v[132:135]
    ds_read_b64_tr_b16 a[246:247], v13 offset:62464
    ds_read_b64_tr_b16 a[248:249], v14 offset:61440
    ds_read_b64_tr_b16 a[250:251], v14 offset:62464
    v_mfma_f32_16x16x32_bf16 v[136:139], v[76:79], v[200:203], v[136:139]
    ds_read_b64_tr_b16 a[252:253], v15 offset:61440
    ds_read_b64_tr_b16 a[254:255], v15 offset:62464
    s_waitcnt vmcnt(16)
    v_max3_u32 v253, v80, v84, v88
    v_mfma_f32_16x16x32_bf16 v[140:143], v[76:79], v[204:207], v[140:143]
    v_max_u32 v253, v253, v92
    v_cmp_eq_u32 vcc, -1, v253
    s_cbranch_vccnz L_ro1
L_ro1_b:
    v_mfma_f32_16x16x32_bf16 v[128:131], v[80:83], v[208:211], v[128:131]
    s_mul_i32 s3, s66, 5
    s_cmp_gt_u32 s65, 5
    s_cselect_b32 m0, s60, s61
    s_add_u32 s3, s3, m0
    s_add_u32 m0, s64, 20480
    s_nop 0
    buffer_load_dwordx4 v244, s[16:19], s3 offen lds
    v_mfma_f32_16x16x32_bf16 v[132:135], v[80:83], v[212:215], v[132:135]
    buffer_load_dwordx4 v245, s[16:19], s3 offen offset:1024 lds
    v_mfma_f32_16x16x32_bf16 v[136:139], v[80:83], v[216:219], v[136:139]
    buffer_load_dwordx4 v246, s[16:19], s3 offen offset:2048 lds
    v_mfma_f32_16x16x32_bf16 v[140:143], v[80:83], v[220:223], v[140:143]
    v_mfma_f32_16x16x32_bf16 v[128:131], v[84:87], v[224:227], v[128:131]
    buffer_load_dwordx4 v247, s[16:19], s3 offen offset:3072 lds
    v_mfma_f32_16x16x32_bf16 v[132:135], v[84:87], v[228:231], v[132:135]
    v_mfma_f32_16x16x32_bf16 v[136:139], v[84:87], v[232:235], v[136:139]
    ds_read_b64_tr_b16 a[0:1], v248 offset:0
    v_mfma_f32_16x16x32_bf16 v[140:143], v[84:87], v[236:239], v[140:143]
    ds_read_b64_tr_b16 a[2:3], v248 offset:512
    v_mfma_f32_16x16x32_bf16 v[128:131], v[88:91], a[96:99], v[128:131]
    ds_read_b64_tr_b16 a[4:5], v249 offset:0
    v_mfma_f32_16x16x32_bf16 v[132:135], v[88:91], a[100:103], v[132:135]
    ds_read_b64_tr_b16 a[6:7], v249 offset:512
    v_mfma_f32_16x16x32_bf16 v[136:139], v[88:91], a[104:107], v[136:139]
    ds_read_b64_tr_b16 a[8:9], v250 offset:0
    v_mfma_f32_16x16x32_bf16 v[140:143], v[88:91], a[108:111], v[140:143]
    v_mfma_f32_16x16x32_bf16 v[128:131], v[92:95], a[112:115], v[128:131]
    ds_read_b64_tr_b16 a[10:11], v250 offset:512
    ds_read_b64_tr_b16 a[12:13], v251 offset:0
    ds_read_b64_tr_b16 a[14:15], v251 offset:512
    v_mfma_f32_16x16x32_bf16 v[132:135], v[92:95], a[116:119], v[132:135]
    s_waitcnt vmcnt(16)
    v_mfma_f32_16x16x32_bf16 v[136:139], v[92:95], a[120:123], v[136:139]
    v_max3_u32 v253, v96, v100, v104
    v_max_u32 v253, v253, v108
    v_mfma_f32_16x16x32_bf16 v[140:143], v[92:95], a[124:127], v[140:143]
    v_cmp_eq_u32 vcc, -1, v253
    s_cbranch_vccnz L_ro2
L_ro2_b:
    s_waitcnt lgkmcnt(15)
    v_mfma_f32_16x16x32_bf16 v[128:131], v[96:99], a[128:131], v[128:131]
    ds_read_b64_tr_b16 a[16:17], v248 offset:4096
    v_mfma_f32_16x16x32_bf16 v[132:135], v[96:99], a[132:135], v[132:135]
    ds_read_b64_tr_b16 a[18:19], v248 offset:4608
    v_mfma_f32_16x16x32_bf16 v[136:139], v[96:99], a[136:139], v[136:139]
    ds_read_b64_tr_b16 a[20:21], v249 offset:4096
    v_mfma_f32_16x16x32_bf16 v[140:143], v[96:99], a[140:143], v[140:143]
    v_mfma_f32_16x16x32_bf16 v[128:131], v[100:103], a[144:147], v[128:131]
    ds_read_b64_tr_b16 a[22:23], v249 offset:4608
    v_mfma_f32_16x16x32_bf16 v[132:135], v[100:103], a[148:151], v[132:135]
    ds_read_b64_tr_b16 a[24:25], v250 offset:4096
    v_mfma_f32_16x16x32_bf16 v[136:139], v[100:103], a[152:155], v[136:139]
    ds_read_b64_tr_b16 a[26:27], v250 offset:4608
    v_mfma_f32_16x16x32_bf16 v[140:143], v[100:103], a[156:159], v[140:143]
    v_mfma_f32_16x16x32_bf16 v[128:131], v[104:107], a[160:163], v[128:131]
    ds_read_b64_tr_b16 a[28:29], v251 offset:4096
    v_mfma_f32_16x16x32_bf16 v[132:135], v[104:107], a[164:167], v[132:135]
    ds_read_b64_tr_b16 a[30:31], v251 offset:4608
    v_mfma_f32_16x16x32_bf16 v[136:139], v[104:107], a[168:171], v[136:139]
    s_waitcnt lgkmcnt(8)
    v_mfma_f32_16x16x32_bf16 v[140:143], v[104:107], a[172:175], v[140:143]
    s_mul_i32 s3, s66, 6
    s_cmp_gt_u32 s65, 6
    s_cselect_b32 m0, s60, s61
    s_add_u32 s3, s3, m0
    s_add_u32 m0, s64, 0
    s_nop 0
    buffer_load_dwordx4 v244, s[16:19], s3 offen lds
    v_mfma_f32_16x16x32_bf16 v[128:131], v[108:111], a[176:179], v[128:131]
    buffer_load_dwordx4 v245, s[16:19], s3 offen offset:1024 lds
    buffer_load_dwordx4 v246, s[16:19], s3 offen offset:2048 lds
    v_mfma_f32_16x16x32_bf16 v[132:135], v[108:111], a[180:183], v[132:135]
    buffer_load_dwordx4 v247, s[16:19], s3 offen offset:3072 lds
    s_waitcnt vmcnt(16)
    v_mfma_f32_16x16x32_bf16 v[136:139], v[108:111], a[184:187], v[136:139]
    v_max3_u32 v253, v112, v116, v120
    v_max_u32 v253, v253, v124
    v_mfma_f32_16x16x32_bf16 v[140:143], v[108:111], a[188:191], v[140:143]
    v_cmp_eq_u32 vcc, -1, v253
    s_cbranch_vccnz L_ro3
L_ro3_b:
    v_mfma_f32_16x16x32_bf16 v[128:131], v[112:115], a[192:195], v[128:131]
    v_mfma_f32_16x16x32_bf16 v[132:135], v[112:115], a[196:199], v[132:135]
    ds_read_b64_tr_b16 a[32:33], v248 offset:8192
    v_mfma_f32_16x16x32_bf16 v[136:139], v[112:115], a[200:203], v[136:139]
    ds_read_b64_tr_b16 a[34:35], v248 offset:8704
    v_mfma_f32_16x16x32_bf16 v[140:143], v[112:115], a[204:207], v[140:143]
    v_mfma_f32_16x16x32_bf16 v[128:131], v[116:119], a[208:211], v[128:131]
    ds_read_b64_tr_b16 a[36:37], v249 offset:8192
    v_mfma_f32_16x16x32_bf16 v[132:135], v[116:119], a[212:215], v[132:135]
    ds_read_b64_tr_b16 a[38:39], v249 offset:8704
    v_mfma_f32_16x16x32_bf16 v[136:139], v[116:119], a[216:219], v[136:139]
    ds_read_b64_tr_b16 a[40:41], v250 offset:8192
    v_mfma_f32_16x16x32_bf16 v[140:143], v[116:119], a[220:223], v[140:143]
    ds_read_b64_tr_b16 a[42:43], v250 offset:8704
    v_mfma_f32_16x16x32_bf16 v[128:131], v[120:123], a[224:227], v[128:131]
    ds_read_b64_tr_b16 a[44:45], v251 offset:8192
    v_mfma_f32_16x16x32_bf16 v[132:135], v[120:123], a[228:231], v[132:135]
    ds_read_b64_tr_b16 a[46:47], v251 offset:8704
    v_mfma_f32_16x16x32_bf16 v[136:139], v[120:123], a[232:235], v[136:139]
    s_waitcnt lgkmcnt(8)
    v_mfma_f32_16x16x32_bf16 v[140:143], v[120:123], a[236:239], v[140:143]
    v_mfma_f32_16x16x32_bf16 v[128:131], v[124:127], a[240:243], v[128:131]
    s_mul_i32 s3, s66, 7
    s_cmp_gt_u32 s65, 7
    s_cselect_b32 m0, s60, s61
    s_add_u32 s3, s3, m0
    s_add_u32 m0, s64, 4096
    s_nop 0
    buffer_load_dwordx4 v244, s[16:19], s3 offen lds
    v_mfma_f32_16x16x32_bf16 v[132:135], v[124:127], a[244:247], v[132:135]
    buffer_load_dwordx4 v245, s[16:19], s3 offen offset:1024 lds
    v_mfma_f32_16x16x32_bf16 v[136:139], v[124:127], a[248:251], v[136:139]
    buffer_load_dwordx4 v246, s[16:19], s3 offen offset:2048 lds
    v_mfma_f32_16x16x32_bf16 v[140:143], v[124:127], a[252:255], v[140:143]
    buffer_load_dwordx4 v247, s[16:19], s3 offen offset:3072 lds
    s_nop 2
    v_add_f32 v144, v128, v132
    v_mul_f32 v148, v128, v128
    v_add_f32 v145, v129, v133
    v_mul_f32 v149, v129, v129
    v_add_f32 v146, v130, v134
    v_mul_f32 v150, v130, v130
    v_add_f32 v147, v131, v135
    v_mul_f32 v151, v131, v131
    v_fmac_f32 v148, v132, v132
    v_fmac_f32 v149, v133, v133
    v_fmac_f32 v150, v134, v134
    v_fmac_f32 v151, v135, v135
    v_add_f32 v144, v144, v136
    v_fmac_f32 v148, v136, v136
    v_add_f32 v145, v145, v137
    v_fmac_f32 v149, v137, v137
    v_add_f32 v146, v146, v138
    v_fmac_f32 v150, v138, v138
    v_add_f32 v147, v147, v139
    v_fmac_f32 v151, v139, v139
    v_add_f32 v144, v144, v140
    v_fmac_f32 v148, v140, v140
    v_add_f32 v145, v145, v141
    v_fmac_f32 v149, v141, v141
    v_add_f32 v146, v146, v142
    v_fmac_f32 v150, v142, v142
    v_add_f32 v147, v147, v143
    v_fmac_f32 v151, v143, v143
    v_add_f32_dpp v144, v144, v144 row_ror:8 row_mask:0xf bank_mask:0x3
    v_add_f32_dpp v145, v145, v145 row_ror:8 row_mask:0xf bank_mask:0x3
    v_add_f32_dpp v148, v148, v148 row_ror:8 row_mask:0xf bank_mask:0x3
    v_add_f32_dpp v149, v149, v149 row_ror:8 row_mask:0xf bank_mask:0x3
    v_add_f32_dpp v144, v146, v146 row_ror:8 row_mask:0xf bank_mask:0xc
    v_add_f32_dpp v145, v147, v147 row_ror:8 row_mask:0xf bank_mask:0xc
    v_add_f32_dpp v148, v150, v150 row_ror:8 row_mask:0xf bank_mask:0xc
    v_add_f32_dpp v149, v151, v151 row_ror:8 row_mask:0xf bank_mask:0xc
    v_add_f32_dpp v144, v144, v144 row_half_mirror row_mask:0xf bank_mask:0x5
    v_add_f32_dpp v148, v148, v148 row_half_mirror row_mask:0xf bank_mask:0x5
    s_nop 0
    v_add_f32_dpp v144, v145, v145 row_half_mirror row_mask:0xf bank_mask:0xa
    v_add_f32_dpp v148, v149, v149 row_half_mirror row_mask:0xf bank_mask:0xa
    s_nop 0
    v_add_f32_dpp v144, v144, v144 quad_perm:[1,0,3,2] row_mask:0xf bank_mask:0xf
    v_add_f32_dpp v148, v148, v148 quad_perm:[1,0,3,2] row_mask:0xf bank_mask:0xf
    s_nop 0
    v_add_f32_dpp v144, v144, v144 quad_perm:[2,3,0,1] row_mask:0xf bank_mask:0xf
    v_add_f32_dpp v148, v148, v148 quad_perm:[2,3,0,1] row_mask:0xf bank_mask:0xf
    s_mov_b32 vcc_lo, 0xaaaaaaaa
    s_mov_b32 vcc_hi, 0xaaaaaaaa
    v_cndmask_b32 v144, v144, v148, vcc
    s_mov_b32 vcc_lo, 0xcccccccc
    s_mov_b32 vcc_hi, 0xcccccccc
    v_cndmask_b32 v144, v144, v6, vcc
    buffer_store_dword v144, v4, s[40:43], s48 offen sc1
    v_cvt_pk_bf16_f32 v152, v128, v129
    v_cvt_pk_bf16_f32 v153, v130, v131
    v_cvt_pk_bf16_f32 v154, v132, v133
    v_cvt_pk_bf16_f32 v155, v134, v135
    v_cvt_pk_bf16_f32 v156, v136, v137
    v_cvt_pk_bf16_f32 v157, v138, v139
    v_cvt_pk_bf16_f32 v158, v140, v141
    v_cvt_pk_bf16_f32 v159, v142, v143
    v_permlane16_swap_b32 v152, v154
    v_permlane16_swap_b32 v153, v155
    v_permlane16_swap_b32 v156, v158
    v_permlane16_swap_b32 v157, v159
    buffer_store_dwordx4 v[152:155], v9, s[40:43], s46 offen offset:0 sc1
    buffer_store_dwordx4 v[156:159], v9, s[40:43], s46 offen offset:2048 sc1
    s_lshr_b32 s12, s50, 1
    s_lshl_b32 s12, s12, 11
    s_sub_u32 s46, s46, s12
    s_sub_u32 s46, s46, 0x200000
    s_add_u32 s12, s46, 0x20000
    s_lshl_b32 s48, s55, 7
    s_lshr_b32 s49, s54, 3
    s_add_u32 s48, s48, s49
    s_lshl_b32 s48, s48, 5
    s_and_b32 s49, s54, 7
    s_add_u32 s48, s48, s49
    s_lshl_b32 s48, s48, 2
    s_add_u32 s48, s48, 0x860000
    s_mov_b32 s55, s100
    s_waitcnt vmcnt(19)
    ds_read_b64_tr_b16 a[48:49], v248 offset:12288
    ds_read_b64_tr_b16 a[50:51], v248 offset:12800
    ds_read_b64_tr_b16 a[52:53], v249 offset:12288
    ds_read_b64_tr_b16 a[54:55], v249 offset:12800
    ds_read_b64_tr_b16 a[56:57], v250 offset:12288
    ds_read_b64_tr_b16 a[58:59], v250 offset:12800
    ds_read_b64_tr_b16 a[60:61], v251 offset:12288
    ds_read_b64_tr_b16 a[62:63], v251 offset:12800
    s_waitcnt lgkmcnt(8)
    s_mul_i32 s3, s66, 8
    s_cmp_gt_u32 s65, 8
    s_cselect_b32 m0, s60, s61
    s_add_u32 s3, s3, m0
    s_add_u32 m0, s64, 8192
    s_nop 0
    buffer_load_dwordx4 v244, s[16:19], s3 offen lds
    buffer_load_dwordx4 v245, s[16:19], s3 offen offset:1024 lds
    buffer_load_dwordx4 v246, s[16:19], s3 offen offset:2048 lds
    buffer_load_dwordx4 v247, s[16:19], s3 offen offset:3072 lds
    s_waitcnt vmcnt(19)
    ds_read_b64_tr_b16 a[64:65], v248 offset:16384
    ds_read_b64_tr_b16 a[66:67], v248 offset:16896
    ds_read_b64_tr_b16 a[68:69], v249 offset:16384
    ds_read_b64_tr_b16 a[70:71], v249 offset:16896
    ds_read_b64_tr_b16 a[72:73], v250 offset:16384
    ds_read_b64_tr_b16 a[74:75], v250 offset:16896
    ds_read_b64_tr_b16 a[76:77], v251 offset:16384
    ds_read_b64_tr_b16 a[78:79], v251 offset:16896
    s_waitcnt lgkmcnt(8)
    s_mul_i32 s3, s66, 9
    s_cmp_gt_u32 s65, 9
    s_cselect_b32 m0, s60, s61
    s_add_u32 s3, s3, m0
    s_add_u32 m0, s64, 12288
    s_nop 0
    buffer_load_dwordx4 v244, s[16:19], s3 offen lds
    buffer_load_dwordx4 v245, s[16:19], s3 offen offset:1024 lds
    buffer_load_dwordx4 v246, s[16:19], s3 offen offset:2048 lds
    buffer_load_dwordx4 v247, s[16:19], s3 offen offset:3072 lds
    s_waitcnt vmcnt(19)
    ds_read_b64_tr_b16 a[80:81], v248 offset:20480
    ds_read_b64_tr_b16 a[82:83], v248 offset:20992
    ds_read_b64_tr_b16 a[84:85], v249 offset:20480
    ds_read_b64_tr_b16 a[86:87], v249 offset:20992
    ds_read_b64_tr_b16 a[88:89], v250 offset:20480
    ds_read_b64_tr_b16 a[90:91], v250 offset:20992
    ds_read_b64_tr_b16 a[92:93], v251 offset:20480
    ds_read_b64_tr_b16 a[94:95], v251 offset:20992
    s_waitcnt lgkmcnt(8)
    s_mul_i32 s3, s66, 10
    s_cmp_gt_u32 s65, 10
    s_cselect_b32 m0, s60, s61
    s_add_u32 s3, s3, m0
    s_add_u32 m0, s64, 16384
    s_nop 0
    buffer_load_dwordx4 v244, s[16:19], s3 offen lds
    buffer_load_dwordx4 v245, s[16:19], s3 offen offset:1024 lds
    buffer_load_dwordx4 v246, s[16:19], s3 offen offset:2048 lds
    buffer_load_dwordx4 v247, s[16:19], s3 offen offset:3072 lds
    s_waitcnt vmcnt(19)
    ds_read_b64_tr_b16 a[96:97], v248 offset:0
    ds_read_b64_tr_b16 a[98:99], v248 offset:512
    ds_read_b64_tr_b16 a[100:101], v249 offset:0
    ds_read_b64_tr_b16 a[102:103], v249 offset:512
    ds_read_b64_tr_b16 a[104:105], v250 offset:0
    ds_read_b64_tr_b16 a[106:107], v250 offset:512
    ds_read_b64_tr_b16 a[108:109], v251 offset:0
    ds_read_b64_tr_b16 a[110:111], v251 offset:512
    s_waitcnt lgkmcnt(8)
    s_mul_i32 s3, s66, 11
    s_cmp_gt_u32 s65, 11
    s_cselect_b32 m0, s60, s61
    s_add_u32 s3, s3, m0
    s_add_u32 m0, s64, 20480
    s_nop 0
    buffer_load_dwordx4 v244, s[16:19], s3 offen lds
    buffer_load_dwordx4 v245, s[16:19], s3 offen offset:1024 lds
    buffer_load_dwordx4 v246, s[16:19], s3 offen offset:2048 lds
    buffer_load_dwordx4 v247, s[16:19], s3 offen offset:3072 lds
    s_bitcmp1_b32 s44, 0
    s_cselect_b32 s3, 0, 0x1000080
    s_mov_b32 exec_lo, 0
    s_mov_b32 exec_hi, 0xff00ff00
    v_add_u32 v9, s3, v9
    s_mov_b64 exec, -1
    s_sleep 8
    buffer_load_dwordx4 v[64:67], v10, s[40:43], s47 offen offset:0 sc1
    buffer_load_dwordx4 v[68:71], v10, s[40:43], s47 offen offset:1024 sc1
    s_waitcnt vmcnt(21)
    ds_read_b64_tr_b16 a[112:113], v248 offset:4096
    ds_read_b64_tr_b16 a[114:115], v248 offset:4608
    ds_read_b64_tr_b16 a[116:117], v249 offset:4096
    ds_read_b64_tr_b16 a[118:119], v249 offset:4608
    ds_read_b64_tr_b16 a[120:121], v250 offset:4096
    ds_read_b64_tr_b16 a[122:123], v250 offset:4608
    ds_read_b64_tr_b16 a[124:125], v251 offset:4096
    ds_read_b64_tr_b16 a[126:127], v251 offset:4608
    s_waitcnt lgkmcnt(8)
    s_mul_i32 s3, s66, 12
    s_cmp_gt_u32 s65, 12
    s_cselect_b32 m0, s60, s61
    s_add_u32 s3, s3, m0
    s_add_u32 m0, s64, 0
    s_nop 0
    buffer_load_dwordx4 v244, s[16:19], s3 offen lds
    buffer_load_dwordx4 v245, s[16:19], s3 offen offset:1024 lds
    buffer_load_dwordx4 v246, s[16:19], s3 offen offset:2048 lds
    buffer_load_dwordx4 v247, s[16:19], s3 offen offset:3072 lds
    s_waitcnt vmcnt(18)
    ds_read_b64_tr_b16 a[128:129], v248 offset:8192
    ds_read_b64_tr_b16 a[130:131], v248 offset:8704
    ds_read_b64_tr_b16 a[132:133], v249 offset:8192
    ds_read_b64_tr_b16 a[134:135], v249 offset:8704
    ds_read_b64_tr_b16 a[136:137], v250 offset:8192
    ds_read_b64_tr_b16 a[138:139], v250 offset:8704
    ds_read_b64_tr_b16 a[140:141], v251 offset:8192
    ds_read_b64_tr_b16 a[142:143], v251 offset:8704
    s_waitcnt lgkmcnt(8)
    s_mul_i32 s3, s66, 13
    s_cmp_gt_u32 s65, 13
    s_cselect_b32 m0, s60, s61
    s_add_u32 s3, s3, m0
    s_add_u32 m0, s64, 4096
    s_nop 0
    buffer_load_dwordx4 v244, s[16:19], s3 offen lds
    buffer_load_dwordx4 v245, s[16:19], s3 offen offset:1024 lds
    buffer_load_dwordx4 v246, s[16:19], s3 offen offset:2048 lds
    buffer_load_dwordx4 v247, s[16:19], s3 offen offset:3072 lds
    s_waitcnt vmcnt(18)
    ds_read_b64_tr_b16 a[144:145], v248 offset:12288
    ds_read_b64_tr_b16 a[146:147], v248 offset:12800
    ds_read_b64_tr_b16 a[148:149], v249 offset:12288
    ds_read_b64_tr_b16 a[150:151], v249 offset:12800
    ds_read_b64_tr_b16 a[152:153], v250 offset:12288
    ds_read_b64_tr_b16 a[154:155], v250 offset:12800
    ds_read_b64_tr_b16 a[156:157], v251 offset:12288
    ds_read_b64_tr_b16 a[158:159], v251 offset:12800
    s_waitcnt lgkmcnt(8)
    s_mul_i32 s3, s66, 14
    s_cmp_gt_u32 s65, 14
    s_cselect_b32 m0, s60, s61
    s_add_u32 s3, s3, m0
    s_add_u32 m0, s64, 8192
    s_nop 0
    buffer_load_dwordx4 v244, s[16:19], s3 offen lds
    buffer_load_dwordx4 v245, s[16:19], s3 offen offset:1024 lds
    buffer_load_dwordx4 v246, s[16:19], s3 offen offset:2048 lds
    buffer_load_dwordx4 v247, s[16:19], s3 offen offset:3072 lds
    s_waitcnt vmcnt(18)
    ds_read_b64_tr_b16 a[160:161], v248 offset:16384
    ds_read_b64_tr_b16 a[162:163], v248 offset:16896
    ds_read_b64_tr_b16 a[164:165], v249 offset:16384
    ds_read_b64_tr_b16 a[166:167], v249 offset:16896
    ds_read_b64_tr_b16 a[168:169], v250 offset:16384
    ds_read_b64_tr_b16 a[170:171], v250 offset:16896
    ds_read_b64_tr_b16 a[172:173], v251 offset:16384
    ds_read_b64_tr_b16 a[174:175], v251 offset:16896
    s_waitcnt lgkmcnt(8)
    s_mul_i32 s3, s66, 15
    s_cmp_gt_u32 s65, 15
    s_cselect_b32 m0, s60, s61
    s_add_u32 s3, s3, m0
    s_add_u32 m0, s64, 12288
    s_nop 0
    buffer_load_dwordx4 v244, s[16:19], s3 offen lds
    buffer_load_dwordx4 v245, s[16:19], s3 offen offset:1024 lds
    buffer_load_dwordx4 v246, s[16:19], s3 offen offset:2048 lds
    buffer_load_dwordx4 v247, s[16:19], s3 offen offset:3072 lds
    s_branch L_pb1
.p2alignl 12, 0xbf810000
L_pb1:
    s_waitcnt vmcnt(16)
    v_xor_b32 v66, s68, v66
    v_xor_b32 v70, s68, v70
    v_add_f32 v64, v64, v68
    v_or_b32 v66, v66, v70
    v_add_f32 v65, v65, v69
    v_cmp_ne_u32 vcc, 0, v66
    s_cbranch_vccz L_sx_ok
L_sx:
    s_sub_u32 s45, s45, 1
    s_cbranch_scc1 L_sx_x
    buffer_load_dwordx4 v[64:67], v10, s[40:43], s47 offen offset:0 sc1
    buffer_load_dwordx4 v[68:71], v10, s[40:43], s47 offen offset:1024 sc1
    s_waitcnt vmcnt(0)
    v_xor_b32 v66, s68, v66
    v_xor_b32 v70, s68, v70
    v_add_f32 v64, v64, v68
    v_or_b32 v66, v66, v70
    v_add_f32 v65, v65, v69
    v_cmp_ne_u32 vcc, 0, v66
    s_cbranch_vccnz L_sx
L_sx_ok:
    v_add_f32_dpp v64, v64, v64 row_ror:4 row_mask:0xf bank_mask:0xf
    v_add_f32_dpp v65, v65, v65 row_ror:4 row_mask:0xf bank_mask:0xf
    s_nop 0
    v_add_f32_dpp v64, v64, v64 row_ror:8 row_mask:0xf bank_mask:0xf
    v_add_f32_dpp v65, v65, v65 row_ror:8 row_mask:0xf bank_mask:0xf
    s_mov_b32 s47, 0x3727c5ac
    v_mul_f32 v64, 0xbb000000, v64
    v_mul_f32 v65, 0x3b000000, v65
    v_fma_f32 v65, -v64, v64, v65
    v_max_f32 v65, 0, v65
    v_add_f32 v66, s47, v65
    v_rsq_f32 v66, v66
    s_nop 0
    v_mul_f32 v65, v65, v66
    v_fma_f32 v65, v65, v66, s47
    v_rsq_f32 v65, v65
    s_nop 0
    v_mul_f32 v66, v66, v65
    v_mul_f32 v64, v64, v66
    s_nop 0
    v_mov_b32_dpp v68, v66 quad_perm:[0,0,0,0] row_mask:0xf bank_mask:0xf
    v_mov_b32_dpp v69, v66 quad_perm:[1,1,1,1] row_mask:0xf bank_mask:0xf
    v_mov_b32_dpp v70, v66 quad_perm:[2,2,2,2] row_mask:0xf bank_mask:0xf
    v_mov_b32_dpp v71, v66 quad_perm:[3,3,3,3] row_mask:0xf bank_mask:0xf
    v_mov_b32_dpp v72, v64 quad_perm:[0,0,0,0] row_mask:0xf bank_mask:0xf
    v_mov_b32_dpp v73, v64 quad_perm:[1,1,1,1] row_mask:0xf bank_mask:0xf
    v_mov_b32_dpp v74, v64 quad_perm:[2,2,2,2] row_mask:0xf bank_mask:0xf
    v_mov_b32_dpp v75, v64 quad_perm:[3,3,3,3] row_mask:0xf bank_mask:0xf
    v_pk_fma_f32 v[128:129], v[128:129], v[68:69], v[72:73]
    v_pk_fma_f32 v[130:131], v[130:131], v[70:71], v[74:75]
    v_pk_fma_f32 v[132:133], v[132:133], v[68:69], v[72:73]
    v_pk_fma_f32 v[134:135], v[134:135], v[70:71], v[74:75]
    v_pk_fma_f32 v[136:137], v[136:137], v[68:69], v[72:73]
    v_pk_fma_f32 v[138:139], v[138:139], v[70:71], v[74:75]
    v_pk_fma_f32 v[140:141], v[140:141], v[68:69], v[72:73]
    v_pk_fma_f32 v[142:143], v[142:143], v[70:71], v[74:75]
    v_cvt_pk_bf16_f32 v160, v128, v129
    v_cvt_pk_bf16_f32 v161, v130, v131
    v_cvt_pk_bf16_f32 v162, v132, v133
    v_cvt_pk_bf16_f32 v163, v134, v135
    v_cvt_pk_bf16_f32 v164, v136, v137
    v_cvt_pk_bf16_f32 v165, v138, v139
    v_cvt_pk_bf16_f32 v166, v140, v141
    v_cvt_pk_bf16_f32 v167, v142, v143
    v_permlane16_swap_b32 v160, v162
    v_permlane16_swap_b32 v161, v163
    v_permlane16_swap_b32 v164, v166
    v_permlane16_swap_b32 v165, v167
    buffer_store_dwordx4 v[160:163], v9, s[40:43], s46 offen sc1
    buffer_store_dwordx4 v[164:167], v9, s[40:43], s12 offen sc1
    s_waitcnt lgkmcnt(0)
    s_barrier
    s_cmp_lg_u32 s44, 0
    s_cbranch_scc1 L_nf2
    s_mov_b32 exec_hi, 0
    buffer_store_dword v6, v7, s[40:43], s48 offen sc1
    s_mov_b32 exec_hi, -1
L_nf2:
    s_cmp_ge_u32 s67, 7
    s_cbranch_scc1 L_skip3
    ds_read_b64_tr_b16 a[176:177], v248 offset:20480
    ds_read_b64_tr_b16 a[178:179], v248 offset:20992
    ds_read_b64_tr_b16 a[180:181], v249 offset:20480
    ds_read_b64_tr_b16 a[182:183], v249 offset:20992
    ds_read_b64_tr_b16 a[184:185], v250 offset:20480
    ds_read_b64_tr_b16 a[186:187], v250 offset:20992
    ds_read_b64_tr_b16 a[188:189], v251 offset:20480
    ds_read_b64_tr_b16 a[190:191], v251 offset:20992
    s_cmp_lt_u32 s59, 14
    s_cselect_b32 s3, s62, s63
    s_add_u32 m0, s64, 16384
    s_add_u32 s3, s3, 0
    buffer_load_dwordx4 v240, s[24:27], s3 offen lds
    buffer_load_dwordx4 v241, s[24:27], s3 offen offset:1024 lds
    buffer_load_dwordx4 v242, s[24:27], s3 offen offset:2048 lds
    buffer_load_dwordx4 v243, s[24:27], s3 offen offset:3072 lds
    s_waitcnt vmcnt(18)
    ds_read_b64_tr_b16 a[192:193], v248 offset:0
    ds_read_b64_tr_b16 a[194:195], v248 offset:512
    ds_read_b64_tr_b16 a[196:197], v249 offset:0
    ds_read_b64_tr_b16 a[198:199], v249 offset:512
    ds_read_b64_tr_b16 a[200:201], v250 offset:0
    ds_read_b64_tr_b16 a[202:203], v250 offset:512
    ds_read_b64_tr_b16 a[204:205], v251 offset:0
    ds_read_b64_tr_b16 a[206:207], v251 offset:512
    s_waitcnt lgkmcnt(8)
    s_cmp_lt_u32 s59, 13
    s_cselect_b32 s3, s62, s63
    s_add_u32 m0, s64, 20480
    s_add_u32 s3, s3, 131072
    buffer_load_dwordx4 v240, s[24:27], s3 offen lds
    buffer_load_dwordx4 v241, s[24:27], s3 offen offset:1024 lds
    buffer_load_dwordx4 v242, s[24:27], s3 offen offset:2048 lds
    buffer_load_dwordx4 v243, s[24:27], s3 offen offset:3072 lds
    s_waitcnt vmcnt(18)
    ds_read_b64_tr_b16 a[208:209], v248 offset:4096
    ds_read_b64_tr_b16 a[210:211], v248 offset:4608
    ds_read_b64_tr_b16 a[212:213], v249 offset:4096
    ds_read_b64_tr_b16 a[214:215], v249 offset:4608
    ds_read_b64_tr_b16 a[216:217], v250 offset:4096
    ds_read_b64_tr_b16 a[218:219], v250 offset:4608
    ds_read_b64_tr_b16 a[220:221], v251 offset:4096
    ds_read_b64_tr_b16 a[222:223], v251 offset:4608
    s_waitcnt lgkmcnt(8)
    s_cmp_lt_u32 s59, 12
    s_cselect_b32 s3, s62, s63
    s_add_u32 m0, s64, 0
    s_add_u32 s3, s3, 262144
    buffer_load_dwordx4 v240, s[24:27], s3 offen lds
    buffer_load_dwordx4 v241, s[24:27], s3 offen offset:1024 lds
    buffer_load_dwordx4 v242, s[24:27], s3 offen offset:2048 lds
    buffer_load_dwordx4 v243, s[24:27], s3 offen offset:3072 lds
    s_waitcnt vmcnt(18)
    ds_read_b64_tr_b16 a[224:225], v248 offset:8192
    ds_read_b64_tr_b16 a[226:227], v248 offset:8704
    ds_read_b64_tr_b16 a[228:229], v249 offset:8192
    ds_read_b64_tr_b16 a[230:231], v249 offset:8704
    ds_read_b64_tr_b16 a[232:233], v250 offset:8192
    ds_read_b64_tr_b16 a[234:235], v250 offset:8704
    ds_read_b64_tr_b16 a[236:237], v251 offset:8192
    ds_read_b64_tr_b16 a[238:239], v251 offset:8704
    s_waitcnt lgkmcnt(8)
    s_cmp_lt_u32 s59, 11
    s_cselect_b32 s3, s62, s63
    s_add_u32 m0, s64, 4096
    s_add_u32 s3, s3, 393216
    buffer_load_dwordx4 v240, s[24:27], s3 offen lds
    buffer_load_dwordx4 v241, s[24:27], s3 offen offset:1024 lds
    buffer_load_dwordx4 v242, s[24:27], s3 offen offset:2048 lds
    buffer_load_dwordx4 v243, s[24:27], s3 offen offset:3072 lds
    s_waitcnt vmcnt(18)
    ds_read_b64_tr_b16 a[240:241], v248 offset:12288
    ds_read_b64_tr_b16 a[242:243], v248 offset:12800
    ds_read_b64_tr_b16 a[244:245], v249 offset:12288
    ds_read_b64_tr_b16 a[246:247], v249 offset:12800
    ds_read_b64_tr_b16 a[248:249], v250 offset:12288
    ds_read_b64_tr_b16 a[250:251], v250 offset:12800
    ds_read_b64_tr_b16 a[252:253], v251 offset:12288
    ds_read_b64_tr_b16 a[254:255], v251 offset:12800
    s_waitcnt lgkmcnt(8)
    s_bfe_u32 s53, s2, 131073
    s_lshl2_add_u32 s53, s55, s53
    s_lshl3_add_u32 s53, s53, s67
    s_lshl2_add_u32 s53, s53, s44
    s_lshl_b32 s53, s53, 7
    s_add_u32 s53, s53, 0x860000
    s_load_dwordx8 s[4:11], s[40:41], s53 glc
    s_cmp_lt_u32 s59, 10
    s_cselect_b32 s3, s62, s63
    s_add_u32 m0, s64, 8192
    s_add_u32 s3, s3, 524288
    buffer_load_dwordx4 v240, s[24:27], s3 offen lds
    buffer_load_dwordx4 v241, s[24:27], s3 offen offset:1024 lds
    buffer_load_dwordx4 v242, s[24:27], s3 offen offset:2048 lds
    buffer_load_dwordx4 v243, s[24:27], s3 offen offset:3072 lds
    s_lshr_b32 s46, s44, 1
    s_lshl_b32 s46, s46, 10
    v_or_b32 v17, s46, v0
    v_xor_b32 v18, 1024, v17
    s_lshl_b32 s46, s56, 7
    s_and_b32 s47, s44, 1
    s_lshl_b32 s47, s47, 6
    s_add_u32 s46, s46, s47
    v_lshlrev_b32 v4, 3, v2
    buffer_load_dwordx2 v[20:21], v4, s[20:23], s46 offen offset:0
    buffer_load_dwordx2 v[22:23], v4, s[20:23], s46 offen offset:32
    s_lshl4_add_u32 s46, s44, s58
    s_lshl_b32 s50, s46, 11
    s_lshl_b32 s46, s55, 18
    s_add_u32 s50, s50, s46
    s_add_u32 s50, s50, 0x200000
    s_sub_u32 s51, s50, 32768
L_p2_c:
    s_waitcnt lgkmcnt(0)
    s_xor_b64 s[4:5], s[4:5], s[68:69]
    s_xor_b64 s[6:7], s[6:7], s[68:69]
    s_xor_b64 s[8:9], s[8:9], s[68:69]
    s_xor_b64 s[10:11], s[10:11], s[68:69]
    s_or_b64 s[4:5], s[4:5], s[6:7]
    s_or_b64 s[8:9], s[8:9], s[10:11]
    s_or_b64 s[4:5], s[4:5], s[8:9]
    s_cbranch_scc0 L_p2_ok
    s_load_dwordx8 s[4:11], s[40:41], s53 glc
    s_sub_u32 s45, s45, 1
    s_cbranch_scc0 L_p2_c
    s_mov_b32 s45, 0
    s_waitcnt lgkmcnt(0)
L_p2_ok:
    s_cmp_lt_u32 s58, 16
    s_cselect_b32 s49, s50, s51
    s_add_u32 s49, s49, 0
    buffer_load_dwordx4 v[128:131], v17, s[40:43], s49 offen offset:0 sc1
    buffer_load_dwordx4 v[132:135], v18, s[40:43], s49 offen offset:0 sc1
    buffer_load_dwordx4 v[136:139], v17, s[40:43], s49 offen offset:2048 sc1
    buffer_load_dwordx4 v[140:143], v18, s[40:43], s49 offen offset:2048 sc1
    s_cmp_lt_u32 s58, 14
    s_cselect_b32 s49, s50, s51
    s_add_u32 s49, s49, 4096
    buffer_load_dwordx4 v[144:147], v17, s[40:43], s49 offen offset:0 sc1
    buffer_load_dwordx4 v[148:151], v18, s[40:43], s49 offen offset:0 sc1
    buffer_load_dwordx4 v[152:155], v17, s[40:43], s49 offen offset:2048 sc1
    buffer_load_dwordx4 v[156:159], v18, s[40:43], s49 offen offset:2048 sc1
    s_cmp_lt_u32 s58, 12
    s_cselect_b32 s49, s50, s51
    s_add_u32 s49, s49, 8192
    buffer_load_dwordx4 v[160:163], v17, s[40:43], s49 offen offset:0 sc1
    buffer_load_dwordx4 v[164:167], v18, s[40:43], s49 offen offset:0 sc1
    buffer_load_dwordx4 v[168:171], v17, s[40:43], s49 offen offset:2048 sc1
    buffer_load_dwordx4 v[172:175], v18, s[40:43], s49 offen offset:2048 sc1
    s_cmp_lt_u32 s58, 10
    s_cselect_b32 s49, s50, s51
    s_add_u32 s49, s49, 12288
    buffer_load_dwordx4 v[176:179], v17, s[40:43], s49 offen offset:0 sc1
    buffer_load_dwordx4 v[180:183], v18, s[40:43], s49 offen offset:0 sc1
    buffer_load_dwordx4 v[184:187], v17, s[40:43], s49 offen offset:2048 sc1
    buffer_load_dwordx4 v[188:191], v18, s[40:43], s49 offen offset:2048 sc1
    s_sub_u32 s46, s64, s52
    v_subrev_u32 v244, s46, v28
    v_subrev_u32 v245, s46, v29
    v_subrev_u32 v246, s46, v30
    v_subrev_u32 v247, s46, v31
    s_waitcnt vmcnt(12)
    v_max3_u32 v253, v128, v132, v136
    v_max_u32 v253, v253, v140
    v_cmp_eq_u32 vcc, -1, v253
    s_cbranch_vccnz L_ra1_0
L_ra1_0_b:
    v_mfma_f32_16x16x32_bf16 v[32:35], a[0:3], v[128:131], 0
    s_cmp_lt_u32 s58, 8
    v_mfma_f32_16x16x32_bf16 v[48:51], a[0:3], v[132:135], 0
    s_cselect_b32 s49, s50, s51
    v_mfma_f32_16x16x32_bf16 v[52:55], a[4:7], v[132:135], 0
    v_mfma_f32_16x16x32_bf16 v[36:39], a[4:7], v[128:131], 0
    s_add_u32 s49, s49, 16384
    v_mfma_f32_16x16x32_bf16 v[40:43], a[8:11], v[128:131], 0
    buffer_load_dwordx4 v[192:195], v17, s[40:43], s49 offen offset:0 sc1
    v_mfma_f32_16x16x32_bf16 v[56:59], a[8:11], v[132:135], 0
    v_mfma_f32_16x16x32_bf16 v[60:63], a[12:15], v[132:135], 0
    buffer_load_dwordx4 v[196:199], v18, s[40:43], s49 offen offset:0 sc1
    v_mfma_f32_16x16x32_bf16 v[44:47], a[12:15], v[128:131], 0
    buffer_load_dwordx4 v[200:203], v17, s[40:43], s49 offen offset:2048 sc1
    v_mfma_f32_16x16x32_bf16 v[32:35], a[16:19], v[136:139], v[32:35]
    v_mfma_f32_16x16x32_bf16 v[48:51], a[16:19], v[140:143], v[48:51]
    buffer_load_dwordx4 v[204:207], v18, s[40:43], s49 offen offset:2048 sc1
    v_mfma_f32_16x16x32_bf16 v[52:55], a[20:23], v[140:143], v[52:55]
    v_mfma_f32_16x16x32_bf16 v[36:39], a[20:23], v[136:139], v[36:39]
    s_waitcnt vmcnt(12)
    v_mfma_f32_16x16x32_bf16 v[40:43], a[24:27], v[136:139], v[40:43]
    v_max3_u32 v253, v144, v148, v152
    v_mfma_f32_16x16x32_bf16 v[56:59], a[24:27], v[140:143], v[56:59]
    v_max_u32 v253, v253, v156
    v_mfma_f32_16x16x32_bf16 v[60:63], a[28:31], v[140:143], v[60:63]
    v_cmp_eq_u32 vcc, -1, v253
    v_mfma_f32_16x16x32_bf16 v[44:47], a[28:31], v[136:139], v[44:47]
    s_cbranch_vccnz L_ra1_1
L_ra1_1_b:
    v_mfma_f32_16x16x32_bf16 v[32:35], a[32:35], v[144:147], v[32:35]
    s_mul_i32 s46, s44, 6144
    s_cmp_lt_u32 s58, 6
    v_mfma_f32_16x16x32_bf16 v[48:51], a[32:35], v[148:151], v[48:51]
    s_cselect_b32 s49, s50, s51
    v_mfma_f32_16x16x32_bf16 v[52:55], a[36:39], v[148:151], v[52:55]
    s_add_u32 s49, s49, 20480
    buffer_load_dwordx4 v[208:211], v17, s[40:43], s49 offen offset:0 sc1
    v_mfma_f32_16x16x32_bf16 v[36:39], a[36:39], v[144:147], v[36:39]
    v_add_u32 v12, s46, v8
    v_mfma_f32_16x16x32_bf16 v[40:43], a[40:43], v[144:147], v[40:43]
    s_xor_b32 s47, s44, 1
    buffer_load_dwordx4 v[212:215], v18, s[40:43], s49 offen offset:0 sc1
    v_mfma_f32_16x16x32_bf16 v[56:59], a[40:43], v[148:151], v[56:59]
    s_mul_i32 s47, s47, 6144
    v_mfma_f32_16x16x32_bf16 v[60:63], a[44:47], v[148:151], v[60:63]
    v_add_u32 v9, s47, v8
    s_xor_b32 s47, s44, 2
    v_mfma_f32_16x16x32_bf16 v[44:47], a[44:47], v[144:147], v[44:47]
    buffer_load_dwordx4 v[216:219], v17, s[40:43], s49 offen offset:2048 sc1
    v_mfma_f32_16x16x32_bf16 v[32:35], a[48:51], v[152:155], v[32:35]
    s_mul_i32 s47, s47, 6144
    v_add_u32 v10, s47, v8
    v_mfma_f32_16x16x32_bf16 v[48:51], a[48:51], v[156:159], v[48:51]
    s_xor_b32 s47, s44, 3
    v_mfma_f32_16x16x32_bf16 v[52:55], a[52:55], v[156:159], v[52:55]
    buffer_load_dwordx4 v[220:223], v18, s[40:43], s49 offen offset:2048 sc1
    s_mul_i32 s47, s47, 6144
    v_mfma_f32_16x16x32_bf16 v[36:39], a[52:55], v[152:155], v[36:39]
    v_add_u32 v11, s47, v8
    v_mfma_f32_16x16x32_bf16 v[40:43], a[56:59], v[152:155], v[40:43]
    s_waitcnt vmcnt(12)
    v_max3_u32 v253, v160, v164, v168
    v_mfma_f32_16x16x32_bf16 v[56:59], a[56:59], v[156:159], v[56:59]
    v_max_u32 v253, v253, v172
    v_mfma_f32_16x16x32_bf16 v[60:63], a[60:63], v[156:159], v[60:63]
    v_cmp_eq_u32 vcc, -1, v253
    v_mfma_f32_16x16x32_bf16 v[44:47], a[60:63], v[152:155], v[44:47]
    s_cbranch_vccnz L_ra1_2
L_ra1_2_b:
    v_mfma_f32_16x16x32_bf16 v[32:35], a[64:67], v[160:163], v[32:35]
    s_lshl_b32 s15, s55, 7
    s_cmp_lt_u32 s58, 4
    v_mfma_f32_16x16x32_bf16 v[48:51], a[64:67], v[164:167], v[48:51]
    s_cselect_b32 s49, s50, s51
    v_mfma_f32_16x16x32_bf16 v[52:55], a[68:71], v[164:167], v[52:55]
    s_add_u32 s49, s49, 24576
    v_mfma_f32_16x16x32_bf16 v[36:39], a[68:71], v[160:163], v[36:39]
    buffer_load_dwordx4 v[224:227], v17, s[40:43], s49 offen offset:0 sc1
    s_bfe_u32 s47, s2, 131073
    v_mfma_f32_16x16x32_bf16 v[40:43], a[72:75], v[160:163], v[40:43]
    buffer_load_dwordx4 v[228:231], v18, s[40:43], s49 offen offset:0 sc1
    v_mfma_f32_16x16x32_bf16 v[56:59], a[72:75], v[164:167], v[56:59]
    s_add_u32 s15, s15, s47
    v_mfma_f32_16x16x32_bf16 v[60:63], a[76:79], v[164:167], v[60:63]
    s_lshl_b32 s15, s15, 5
    v_mfma_f32_16x16x32_bf16 v[44:47], a[76:79], v[160:163], v[44:47]
    buffer_load_dwordx4 v[232:235], v17, s[40:43], s49 offen offset:2048 sc1
    s_add_u32 s15, s15, s67
    v_mfma_f32_16x16x32_bf16 v[32:35], a[80:83], v[168:171], v[32:35]
    s_lshl_b32 s15, s15, 2
    v_mfma_f32_16x16x32_bf16 v[48:51], a[80:83], v[172:175], v[48:51]
    buffer_load_dwordx4 v[236:239], v18, s[40:43], s49 offen offset:2048 sc1
    v_mfma_f32_16x16x32_bf16 v[52:55], a[84:87], v[172:175], v[52:55]
    s_add_u32 s15, s15, 0x880000
    v_mfma_f32_16x16x32_bf16 v[36:39], a[84:87], v[168:171], v[36:39]
    s_waitcnt vmcnt(12)
    v_mfma_f32_16x16x32_bf16 v[40:43], a[88:91], v[168:171], v[40:43]
    v_max3_u32 v253, v176, v180, v184
    v_mfma_f32_16x16x32_bf16 v[56:59], a[88:91], v[172:175], v[56:59]
    v_max_u32 v253, v253, v188
    v_mfma_f32_16x16x32_bf16 v[60:63], a[92:95], v[172:175], v[60:63]
    v_cmp_eq_u32 vcc, -1, v253
    v_mfma_f32_16x16x32_bf16 v[44:47], a[92:95], v[168:171], v[44:47]
    s_cbranch_vccnz L_ra1_3
L_ra1_3_b:
    v_mfma_f32_16x16x32_bf16 v[32:35], a[96:99], v[176:179], v[32:35]
    s_mul_i32 s14, s55, 56
    s_cmp_lt_u32 s58, 2
    v_mfma_f32_16x16x32_bf16 v[48:51], a[96:99], v[180:183], v[48:51]
    s_cselect_b32 s49, s50, s51
    s_add_u32 s49, s49, 28672
    v_mfma_f32_16x16x32_bf16 v[52:55], a[100:103], v[180:183], v[52:55]
    buffer_load_dwordx4 v[128:131], v17, s[40:43], s49 offen offset:0 sc1
    s_add_u32 s14, s14, s56
    v_mfma_f32_16x16x32_bf16 v[36:39], a[100:103], v[176:179], v[36:39]
    s_and_b32 s47, s44, 1
    s_lshl1_add_u32 s14, s14, s47
    v_mfma_f32_16x16x32_bf16 v[40:43], a[104:107], v[176:179], v[40:43]
    s_lshl_b32 s14, s14, 11
    v_mfma_f32_16x16x32_bf16 v[56:59], a[104:107], v[180:183], v[56:59]
    buffer_load_dwordx4 v[132:135], v18, s[40:43], s49 offen offset:0 sc1
    s_add_u32 s14, s14, 0x600000
    v_mfma_f32_16x16x32_bf16 v[60:63], a[108:111], v[180:183], v[60:63]
    v_mov_b32 v104, 0xbdd2d3e8
    v_mov_b32 v105, 0xc0135761
    v_mfma_f32_16x16x32_bf16 v[44:47], a[108:111], v[176:179], v[44:47]
    v_lshlrev_b32 v96, 16, v20
    buffer_load_dwordx4 v[136:139], v17, s[40:43], s49 offen offset:2048 sc1
    v_mfma_f32_16x16x32_bf16 v[32:35], a[112:115], v[184:187], v[32:35]
    v_and_b32 v97, 0xffff0000, v20
    v_mfma_f32_16x16x32_bf16 v[48:51], a[112:115], v[188:191], v[48:51]
    v_lshlrev_b32 v98, 16, v21
    v_and_b32 v99, 0xffff0000, v21
    v_mfma_f32_16x16x32_bf16 v[52:55], a[116:119], v[188:191], v[52:55]
    v_lshlrev_b32 v100, 16, v22
    buffer_load_dwordx4 v[140:143], v18, s[40:43], s49 offen offset:2048 sc1
    v_mfma_f32_16x16x32_bf16 v[36:39], a[116:119], v[184:187], v[36:39]
    v_and_b32 v101, 0xffff0000, v22
    v_lshlrev_b32 v102, 16, v23
    v_mfma_f32_16x16x32_bf16 v[40:43], a[120:123], v[184:187], v[40:43]
    v_and_b32 v103, 0xffff0000, v23
    v_mfma_f32_16x16x32_bf16 v[56:59], a[120:123], v[188:191], v[56:59]
    s_waitcnt vmcnt(12)
    v_max3_u32 v253, v192, v196, v200
    v_mfma_f32_16x16x32_bf16 v[60:63], a[124:127], v[188:191], v[60:63]
    v_max_u32 v253, v253, v204
    v_cmp_eq_u32 vcc, -1, v253
    v_mfma_f32_16x16x32_bf16 v[44:47], a[124:127], v[184:187], v[44:47]
    s_cbranch_vccnz L_ra1_4
L_ra1_4_b:
    v_mfma_f32_16x16x32_bf16 v[32:35], a[128:131], v[192:195], v[32:35]
    s_lshl_b32 s53, s55, 5
    s_cmp_lt_u32 s58, 16
    v_mfma_f32_16x16x32_bf16 v[48:51], a[128:131], v[196:199], v[48:51]
    s_cselect_b32 s49, s50, s51
    s_add_u32 s49, s49, 131072
    v_mfma_f32_16x16x32_bf16 v[52:55], a[132:135], v[196:199], v[52:55]
    buffer_load_dwordx4 v[144:147], v17, s[40:43], s49 offen offset:0 sc1
    s_add_u32 s53, s53, s57
    v_mfma_f32_16x16x32_bf16 v[36:39], a[132:135], v[192:195], v[36:39]
    s_lshl2_add_u32 s53, s53, s44
    s_lshl_b32 s53, s53, 7
    v_mfma_f32_16x16x32_bf16 v[40:43], a[136:139], v[192:195], v[40:43]
    s_add_u32 s53, s53, 0x880000
    buffer_load_dwordx4 v[148:151], v18, s[40:43], s49 offen offset:0 sc1
    v_mfma_f32_16x16x32_bf16 v[56:59], a[136:139], v[196:199], v[56:59]
    s_mul_i32 s46, s44, 14
    s_add_u32 s46, s46, s59
    v_mfma_f32_16x16x32_bf16 v[60:63], a[140:143], v[196:199], v[60:63]
    s_lshl_b32 s12, s46, 11
    s_mul_i32 s46, s55, 229376
    v_mfma_f32_16x16x32_bf16 v[44:47], a[140:143], v[192:195], v[44:47]
    s_add_u32 s12, s12, s46
    buffer_load_dwordx4 v[152:155], v17, s[40:43], s49 offen offset:2048 sc1
    v_mfma_f32_16x16x32_bf16 v[32:35], a[144:147], v[200:203], v[32:35]
    s_add_u32 s12, s12, 0x600000
    s_sub_u32 s13, s12, 28672
    v_mfma_f32_16x16x32_bf16 v[48:51], a[144:147], v[204:207], v[48:51]
    s_lshl2_add_u32 s16, s57, s44
    s_lshl_b32 s46, s16, 5
    v_mfma_f32_16x16x32_bf16 v[52:55], a[148:151], v[204:207], v[52:55]
    v_lshlrev_b32 v4, 1, v3
    buffer_load_dwordx4 v[156:159], v18, s[40:43], s49 offen offset:2048 sc1
    v_mfma_f32_16x16x32_bf16 v[36:39], a[148:151], v[200:203], v[36:39]
    buffer_load_ushort v26, v4, s[28:31], s46 offen
    s_lshl_b32 s16, s16, 7
    v_mfma_f32_16x16x32_bf16 v[40:43], a[152:155], v[200:203], v[40:43]
    s_add_u32 s16, s16, s55
    s_lshl_b32 s16, s16, 7
    v_mfma_f32_16x16x32_bf16 v[56:59], a[152:155], v[204:207], v[56:59]
    s_waitcnt vmcnt(13)
    v_max3_u32 v253, v208, v212, v216
    v_mfma_f32_16x16x32_bf16 v[60:63], a[156:159], v[204:207], v[60:63]
    v_max_u32 v253, v253, v220
    v_cmp_eq_u32 vcc, -1, v253
    v_mfma_f32_16x16x32_bf16 v[44:47], a[156:159], v[200:203], v[44:47]
    s_cbranch_vccnz L_ra1_5
L_ra1_5_b:
    v_mfma_f32_16x16x32_bf16 v[32:35], a[160:163], v[208:211], v[32:35]
    v_lshrrev_b32 v19, 3, v3
    s_cmp_lt_u32 s58, 14
    v_mfma_f32_16x16x32_bf16 v[48:51], a[160:163], v[212:215], v[48:51]
    s_cselect_b32 s49, s50, s51
    s_add_u32 s49, s49, 135168
    v_mfma_f32_16x16x32_bf16 v[52:55], a[164:167], v[212:215], v[52:55]
    buffer_load_dwordx4 v[160:163], v17, s[40:43], s49 offen offset:0 sc1
    v_mfma_f32_16x16x32_bf16 v[36:39], a[164:167], v[208:211], v[36:39]
    v_and_b32 v5, 1, v3
    v_lshl_add_u32 v19, v5, 1, v19
    v_mfma_f32_16x16x32_bf16 v[40:43], a[168:171], v[208:211], v[40:43]
    v_bfe_u32 v5, v3, 1, 1
    buffer_load_dwordx4 v[164:167], v18, s[40:43], s49 offen offset:0 sc1
    v_mfma_f32_16x16x32_bf16 v[56:59], a[168:171], v[212:215], v[56:59]
    v_lshlrev_b32 v5, 4, v5
    v_mfma_f32_16x16x32_bf16 v[60:63], a[172:175], v[212:215], v[60:63]
    v_mov_b32 v24, 0x3f80
    v_lshlrev_b32 v5, v5, v24
    v_mfma_f32_16x16x32_bf16 v[44:47], a[172:175], v[208:211], v[44:47]
    buffer_load_dwordx4 v[168:171], v17, s[40:43], s49 offen offset:2048 sc1
    v_cmp_eq_u32 vcc, v19, v2
    v_mfma_f32_16x16x32_bf16 v[32:35], a[176:179], v[216:219], v[32:35]
    s_nop 0
    v_cndmask_b32 v5, 0, v5, vcc
    v_mfma_f32_16x16x32_bf16 v[48:51], a[176:179], v[220:223], v[48:51]
    v_and_b32 v19, 4, v3
    buffer_load_dwordx4 v[172:175], v18, s[40:43], s49 offen offset:2048 sc1
    v_mfma_f32_16x16x32_bf16 v[52:55], a[180:183], v[220:223], v[52:55]
    v_cmp_eq_u32 vcc, 0, v19
    s_nop 1
    v_cndmask_b32 v24, 0, v5, vcc
    v_mfma_f32_16x16x32_bf16 v[36:39], a[180:183], v[216:219], v[36:39]
    v_cndmask_b32_e64 v25, v5, 0, vcc
    v_mfma_f32_16x16x32_bf16 v[40:43], a[184:187], v[216:219], v[40:43]
    s_waitcnt vmcnt(13)
    v_max3_u32 v253, v224, v228, v232
    v_mfma_f32_16x16x32_bf16 v[56:59], a[184:187], v[220:223], v[56:59]
    v_max_u32 v253, v253, v236
    v_mfma_f32_16x16x32_bf16 v[60:63], a[188:191], v[220:223], v[60:63]
    v_cmp_eq_u32 vcc, -1, v253
    v_mfma_f32_16x16x32_bf16 v[44:47], a[188:191], v[216:219], v[44:47]
    s_cbranch_vccnz L_ra1_6
L_ra1_6_b:
    v_mfma_f32_16x16x32_bf16 v[32:35], a[192:195], v[224:227], v[32:35]
    s_bfe_u32 s5, s2, 131073
    s_cmp_lt_u32 s58, 12
    v_mfma_f32_16x16x32_bf16 v[48:51], a[192:195], v[228:231], v[48:51]
    s_cselect_b32 s49, s50, s51
    s_add_u32 s49, s49, 139264
    v_mfma_f32_16x16x32_bf16 v[52:55], a[196:199], v[228:231], v[52:55]
    buffer_load_dwordx4 v[176:179], v17, s[40:43], s49 offen offset:0 sc1
    s_sub_u32 s5, s5, s44
    v_mfma_f32_16x16x32_bf16 v[36:39], a[196:199], v[224:227], v[36:39]
    s_lshl_b32 s5, s5, 7
    s_add_u32 s5, s5, s53
    v_mfma_f32_16x16x32_bf16 v[40:43], a[200:203], v[224:227], v[40:43]
    s_load_dword s4, s[40:41], s5 offset:28 glc
    buffer_load_dwordx4 v[180:183], v18, s[40:43], s49 offen offset:0 sc1
    v_mfma_f32_16x16x32_bf16 v[56:59], a[200:203], v[228:231], v[56:59]
    v_lshrrev_b32 v19, 1, v2
    v_lshlrev_b32 v13, 17, v19
    v_mfma_f32_16x16x32_bf16 v[60:63], a[204:207], v[228:231], v[60:63]
    v_lshl_add_u32 v13, v3, 4, v13
    v_and_b32 v5, 1, v2
    v_mfma_f32_16x16x32_bf16 v[44:47], a[204:207], v[224:227], v[44:47]
    v_lshl_add_u32 v13, v5, 3, v13
    buffer_load_dwordx4 v[184:187], v17, s[40:43], s49 offen offset:2048 sc1
    v_mfma_f32_16x16x32_bf16 v[32:35], a[208:211], v[232:235], v[32:35]
    v_lshlrev_b32 v14, 10, v3
    v_lshl_add_u32 v14, v5, 5, v14
    v_mfma_f32_16x16x32_bf16 v[48:51], a[208:211], v[236:239], v[48:51]
    v_lshl_add_u32 v14, v19, 4, v14
    s_lshl_b32 s17, s55, 6
    v_mfma_f32_16x16x32_bf16 v[52:55], a[212:215], v[236:239], v[52:55]
    buffer_load_dwordx4 v[188:191], v18, s[40:43], s49 offen offset:2048 sc1
    s_add_u32 s17, s17, s57
    v_mfma_f32_16x16x32_bf16 v[36:39], a[212:215], v[232:235], v[36:39]
    s_lshl4_add_u32 s17, s17, s44
    s_lshl_b32 s17, s17, 8
    v_mfma_f32_16x16x32_bf16 v[40:43], a[216:219], v[232:235], v[40:43]
    s_add_u32 s17, s17, 0x400000
    v_mfma_f32_16x16x32_bf16 v[56:59], a[216:219], v[236:239], v[56:59]
    s_waitcnt vmcnt(13)
    v_max3_u32 v253, v128, v132, v136
    v_mfma_f32_16x16x32_bf16 v[60:63], a[220:223], v[236:239], v[60:63]
    v_max_u32 v253, v253, v140
    v_cmp_eq_u32 vcc, -1, v253
    v_mfma_f32_16x16x32_bf16 v[44:47], a[220:223], v[232:235], v[44:47]
    s_cbranch_vccnz L_ra1_7
L_ra1_7_b:
    v_mfma_f32_16x16x32_bf16 v[56:59], a[232:235], v[132:135], v[56:59]
    s_cmp_lt_u32 s58, 10
    v_mfma_f32_16x16x32_bf16 v[60:63], a[236:239], v[132:135], v[60:63]
    s_cselect_b32 s49, s50, s51
    v_mfma_f32_16x16x32_bf16 v[56:59], a[248:251], v[140:143], v[56:59]
    s_add_u32 s49, s49, 143360
    v_mfma_f32_16x16x32_bf16 v[60:63], a[252:255], v[140:143], v[60:63]
    buffer_load_dwordx4 v[192:195], v17, s[40:43], s49 offen offset:0 sc1
    v_mfma_f32_16x16x32_bf16 v[48:51], a[224:227], v[132:135], v[48:51]
    buffer_load_dwordx4 v[196:199], v18, s[40:43], s49 offen offset:0 sc1
    v_mfma_f32_16x16x32_bf16 v[52:55], a[228:231], v[132:135], v[52:55]
    buffer_load_dwordx4 v[200:203], v17, s[40:43], s49 offen offset:2048 sc1
    v_mfma_f32_16x16x32_bf16 v[48:51], a[240:243], v[140:143], v[48:51]
    buffer_load_dwordx4 v[204:207], v18, s[40:43], s49 offen offset:2048 sc1
    v_mfma_f32_16x16x32_bf16 v[52:55], a[244:247], v[140:143], v[52:55]
    ds_write_b128 v11, v[56:59] offset:4096
    v_mfma_f32_16x16x32_bf16 v[40:43], a[232:235], v[128:131], v[40:43]
    v_mfma_f32_16x16x32_bf16 v[44:47], a[236:239], v[128:131], v[44:47]
    ds_write_b128 v11, v[60:63] offset:5120
    v_mfma_f32_16x16x32_bf16 v[40:43], a[248:251], v[136:139], v[40:43]
    v_mfma_f32_16x16x32_bf16 v[44:47], a[252:255], v[136:139], v[44:47]
    ds_write_b128 v10, v[48:51] offset:2048
    v_mfma_f32_16x16x32_bf16 v[32:35], a[224:227], v[128:131], v[32:35]
    v_mfma_f32_16x16x32_bf16 v[36:39], a[228:231], v[128:131], v[36:39]
    ds_write_b128 v10, v[52:55] offset:3072
    v_mfma_f32_16x16x32_bf16 v[32:35], a[240:243], v[136:139], v[32:35]
    v_mfma_f32_16x16x32_bf16 v[36:39], a[244:247], v[136:139], v[36:39]
    s_nop 0
    ds_write_b128 v9, v[40:43] offset:0
    ds_write_b128 v9, v[44:47] offset:1024
    s_waitcnt vmcnt(13)
    v_max3_u32 v253, v144, v148, v152
    v_max_u32 v253, v253, v156
    v_cmp_eq_u32 vcc, -1, v253
    s_cbranch_vccnz L_ra1_8
L_ra1_8_b:
    v_mfma_f32_16x16x32_bf16 v[64:67], a[0:3], v[144:147], 0
    s_cmp_lt_u32 s58, 8
    v_mfma_f32_16x16x32_bf16 v[80:83], a[0:3], v[148:151], 0
    s_cselect_b32 s49, s50, s51
    v_mfma_f32_16x16x32_bf16 v[84:87], a[4:7], v[148:151], 0
    v_mfma_f32_16x16x32_bf16 v[68:71], a[4:7], v[144:147], 0
    s_add_u32 s49, s49, 147456
    v_mfma_f32_16x16x32_bf16 v[72:75], a[8:11], v[144:147], 0
    buffer_load_dwordx4 v[208:211], v17, s[40:43], s49 offen offset:0 sc1
    v_mfma_f32_16x16x32_bf16 v[88:91], a[8:11], v[148:151], 0
    s_waitcnt lgkmcnt(0)
    s_cmp_eq_u32 s4, s68
    s_cbranch_scc0 L_uw
L_uw_b:
    s_barrier
    ds_read_b128 v[40:43], v12 offset:0
    ds_read_b128 v[48:51], v12 offset:2048
    ds_read_b128 v[56:59], v12 offset:4096
    ds_read_b128 v[44:47], v12 offset:1024
    ds_read_b128 v[52:55], v12 offset:3072
    ds_read_b128 v[60:63], v12 offset:5120
    v_mfma_f32_16x16x32_bf16 v[92:95], a[12:15], v[148:151], 0
    v_mfma_f32_16x16x32_bf16 v[76:79], a[12:15], v[144:147], 0
    s_cmp_lt_u32 s59, 9
    v_mfma_f32_16x16x32_bf16 v[64:67], a[16:19], v[152:155], v[64:67]
    s_cselect_b32 s3, s62, s63
    v_mfma_f32_16x16x32_bf16 v[80:83], a[16:19], v[156:159], v[80:83]
    s_add_u32 m0, s64, 12288
    v_mfma_f32_16x16x32_bf16 v[84:87], a[20:23], v[156:159], v[84:87]
    s_add_u32 s3, s3, 655360
    v_mfma_f32_16x16x32_bf16 v[68:71], a[20:23], v[152:155], v[68:71]
    buffer_load_dwordx4 v240, s[24:27], s3 offen lds
    v_mfma_f32_16x16x32_bf16 v[72:75], a[24:27], v[152:155], v[72:75]
    buffer_load_dwordx4 v[212:215], v18, s[40:43], s49 offen offset:0 sc1
    v_mfma_f32_16x16x32_bf16 v[88:91], a[24:27], v[156:159], v[88:91]
    buffer_load_dwordx4 v[216:219], v17, s[40:43], s49 offen offset:2048 sc1
    v_mfma_f32_16x16x32_bf16 v[92:95], a[28:31], v[156:159], v[92:95]
    buffer_load_dwordx4 v[220:223], v18, s[40:43], s49 offen offset:2048 sc1
    v_mfma_f32_16x16x32_bf16 v[76:79], a[28:31], v[152:155], v[76:79]
    v_pk_add_f32 v[32:33], v[32:33], v[96:97]
    s_cmp_lt_u32 s58, 6
    s_cselect_b32 s49, s50, s51
    s_add_u32 s49, s49, 151552
    buffer_load_dwordx4 v[224:227], v17, s[40:43], s49 offen offset:0 sc1
    v_pk_add_f32 v[34:35], v[34:35], v[98:99]
    v_pk_add_f32 v[36:37], v[36:37], v[100:101]
    v_pk_add_f32 v[38:39], v[38:39], v[102:103]
    buffer_load_dwordx4 v[228:231], v18, s[40:43], s49 offen offset:0 sc1
    s_waitcnt lgkmcnt(3)
    v_pk_add_f32 v[40:41], v[40:41], v[48:49]
    v_pk_add_f32 v[42:43], v[42:43], v[50:51]
    buffer_load_dwordx4 v[232:235], v17, s[40:43], s49 offen offset:2048 sc1
    v_pk_add_f32 v[32:33], v[32:33], v[56:57]
    v_pk_add_f32 v[34:35], v[34:35], v[58:59]
    s_waitcnt lgkmcnt(0)
    v_pk_add_f32 v[44:45], v[44:45], v[52:53]
    buffer_load_dwordx4 v[236:239], v18, s[40:43], s49 offen offset:2048 sc1
    v_pk_add_f32 v[46:47], v[46:47], v[54:55]
    v_pk_add_f32 v[36:37], v[36:37], v[60:61]
    v_pk_add_f32 v[38:39], v[38:39], v[62:63]
    s_cmp_lt_u32 s58, 4
    s_cselect_b32 s49, s50, s51
    s_add_u32 s49, s49, 155648
    buffer_load_dwordx4 v[128:131], v17, s[40:43], s49 offen offset:0 sc1
    v_pk_add_f32 v[32:33], v[32:33], v[40:41]
    v_pk_add_f32 v[34:35], v[34:35], v[42:43]
    v_pk_add_f32 v[36:37], v[36:37], v[44:45]
    buffer_load_dwordx4 v[132:135], v18, s[40:43], s49 offen offset:0 sc1
    v_pk_add_f32 v[38:39], v[38:39], v[46:47]
    v_pk_mul_f32 v[120:121], v[32:33], v[32:33]
    v_pk_mul_f32 v[122:123], v[34:35], v[34:35]
    v_pk_mul_f32 v[124:125], v[36:37], v[36:37]
    buffer_load_dwordx4 v[136:139], v17, s[40:43], s49 offen offset:2048 sc1
    v_pk_mul_f32 v[126:127], v[38:39], v[38:39]
    v_pk_fma_f32 v[120:121], v[120:121], v[104:105], v[104:105] op_sel:[0,0,1] op_sel_hi:[1,0,1]
    v_pk_fma_f32 v[122:123], v[122:123], v[104:105], v[104:105] op_sel:[0,0,1] op_sel_hi:[1,0,1]
    buffer_load_dwordx4 v[140:143], v18, s[40:43], s49 offen offset:2048 sc1
    v_pk_fma_f32 v[124:125], v[124:125], v[104:105], v[104:105] op_sel:[0,0,1] op_sel_hi:[1,0,1]
    v_pk_fma_f32 v[126:127], v[126:127], v[104:105], v[104:105] op_sel:[0,0,1] op_sel_hi:[1,0,1]
    v_pk_mul_f32 v[120:121], v[120:121], v[32:33]
    buffer_load_dwordx4 v241, s[24:27], s3 offen offset:1024 lds
    v_pk_mul_f32 v[122:123], v[122:123], v[34:35]
    v_pk_mul_f32 v[124:125], v[124:125], v[36:37]
    v_pk_mul_f32 v[126:127], v[126:127], v[38:39]
    v_exp_f32 v120, v120
    buffer_load_dwordx4 v242, s[24:27], s3 offen offset:2048 lds
    v_exp_f32 v121, v121
    v_exp_f32 v122, v122
    v_exp_f32 v123, v123
    buffer_load_dwordx4 v243, s[24:27], s3 offen offset:3072 lds
    v_exp_f32 v124, v124
    v_exp_f32 v125, v125
    v_exp_f32 v126, v126
    s_cmp_lt_u32 s59, 8
    s_cselect_b32 s3, s62, s63
    s_add_u32 m0, s52, 49152
    s_add_u32 s3, s3, 786432
    buffer_load_dwordx4 v240, s[24:27], s3 offen lds
    v_exp_f32 v127, v127
    v_pk_add_f32 v[120:121], v[120:121], 1.0 op_sel_hi:[1,0]
    v_pk_add_f32 v[122:123], v[122:123], 1.0 op_sel_hi:[1,0]
    v_pk_add_f32 v[124:125], v[124:125], 1.0 op_sel_hi:[1,0]
    buffer_load_dwordx4 v241, s[24:27], s3 offen offset:1024 lds
    v_pk_add_f32 v[126:127], v[126:127], 1.0 op_sel_hi:[1,0]
    v_rcp_f32 v120, v120
    v_rcp_f32 v121, v121
    buffer_load_dwordx4 v242, s[24:27], s3 offen offset:2048 lds
    v_rcp_f32 v122, v122
    v_rcp_f32 v123, v123
    v_rcp_f32 v124, v124
    buffer_load_dwordx4 v243, s[24:27], s3 offen offset:3072 lds
    v_rcp_f32 v125, v125
    v_rcp_f32 v126, v126
    v_rcp_f32 v127, v127
    v_pk_mul_f32 v[32:33], v[120:121], v[32:33]
    v_pk_mul_f32 v[34:35], v[122:123], v[34:35]
    v_pk_mul_f32 v[36:37], v[124:125], v[36:37]
    v_pk_mul_f32 v[38:39], v[126:127], v[38:39]
    v_cvt_pk_bf16_f32 v108, v32, v33
    v_cvt_pk_bf16_f32 v109, v34, v35
    v_cvt_pk_bf16_f32 v110, v36, v37
    v_cvt_pk_bf16_f32 v111, v38, v39
    buffer_store_dwordx4 v[108:111], v17, s[40:43], s14 offen sc1
    s_add_u32 s14, s14, 114688
    s_cmp_lg_u32 s44, 0
    s_cbranch_scc1 L_nf3
    s_mov_b32 exec_hi, 0
    buffer_store_dword v6, v7, s[40:43], s15 offen offset:0 sc1
    s_mov_b32 exec_hi, -1
L_nf3:
    s_waitcnt vmcnt(29)
    v_max3_u32 v253, v160, v164, v168
    v_max_u32 v253, v253, v172
    v_cmp_eq_u32 vcc, -1, v253
    s_cbranch_vccnz L_ra1_9
L_ra1_9_b:
    v_mfma_f32_16x16x32_bf16 v[64:67], a[32:35], v[160:163], v[64:67]
    ds_read_b64_tr_b16 a[0:1], v28 offset:16384
    v_mfma_f32_16x16x32_bf16 v[80:83], a[32:35], v[164:167], v[80:83]
    ds_read_b64_tr_b16 a[2:3], v28 offset:16896
    v_mfma_f32_16x16x32_bf16 v[84:87], a[36:39], v[164:167], v[84:87]
    ds_read_b64_tr_b16 a[4:5], v29 offset:16384
    ds_read_b64_tr_b16 a[6:7], v29 offset:16896
    v_mfma_f32_16x16x32_bf16 v[68:71], a[36:39], v[160:163], v[68:71]
    ds_read_b64_tr_b16 a[8:9], v30 offset:16384
    v_mfma_f32_16x16x32_bf16 v[72:75], a[40:43], v[160:163], v[72:75]
    ds_read_b64_tr_b16 a[10:11], v30 offset:16896
    ds_read_b64_tr_b16 a[12:13], v31 offset:16384
    v_mfma_f32_16x16x32_bf16 v[88:91], a[40:43], v[164:167], v[88:91]
    ds_read_b64_tr_b16 a[14:15], v31 offset:16896
    v_mfma_f32_16x16x32_bf16 v[92:95], a[44:47], v[164:167], v[92:95]
    ds_read_b64_tr_b16 a[16:17], v28 offset:20480
    v_mfma_f32_16x16x32_bf16 v[76:79], a[44:47], v[160:163], v[76:79]
    ds_read_b64_tr_b16 a[18:19], v28 offset:20992
    v_mfma_f32_16x16x32_bf16 v[64:67], a[48:51], v[168:171], v[64:67]
    ds_read_b64_tr_b16 a[20:21], v29 offset:20480
    ds_read_b64_tr_b16 a[22:23], v29 offset:20992
    v_mfma_f32_16x16x32_bf16 v[80:83], a[48:51], v[172:175], v[80:83]
    ds_read_b64_tr_b16 a[24:25], v30 offset:20480
    v_mfma_f32_16x16x32_bf16 v[84:87], a[52:55], v[172:175], v[84:87]
    ds_read_b64_tr_b16 a[26:27], v30 offset:20992
    ds_read_b64_tr_b16 a[28:29], v31 offset:20480
    v_mfma_f32_16x16x32_bf16 v[68:71], a[52:55], v[168:171], v[68:71]
    ds_read_b64_tr_b16 a[30:31], v31 offset:20992
    v_mfma_f32_16x16x32_bf16 v[72:75], a[56:59], v[168:171], v[72:75]
    s_waitcnt vmcnt(25)
    v_max3_u32 v253, v176, v180, v184
    v_mfma_f32_16x16x32_bf16 v[88:91], a[56:59], v[172:175], v[88:91]
    v_max_u32 v253, v253, v188
    v_mfma_f32_16x16x32_bf16 v[92:95], a[60:63], v[172:175], v[92:95]
    v_cmp_eq_u32 vcc, -1, v253
    v_mfma_f32_16x16x32_bf16 v[76:79], a[60:63], v[168:171], v[76:79]
    s_cbranch_vccnz L_ra1_10
L_ra1_10_b:
    v_mfma_f32_16x16x32_bf16 v[64:67], a[64:67], v[176:179], v[64:67]
    s_waitcnt lgkmcnt(8)
    v_mfma_f32_16x16x32_bf16 v[80:83], a[64:67], v[180:183], v[80:83]
    s_cmp_lt_u32 s59, 7
    s_cselect_b32 s3, s62, s63
    v_mfma_f32_16x16x32_bf16 v[84:87], a[68:71], v[180:183], v[84:87]
    s_add_u32 m0, s64, 16384
    s_add_u32 s3, s3, 917504
    v_mfma_f32_16x16x32_bf16 v[68:71], a[68:71], v[176:179], v[68:71]
    buffer_load_dwordx4 v240, s[24:27], s3 offen lds
    ds_read_b64_tr_b16 a[32:33], v28 offset:0
    v_mfma_f32_16x16x32_bf16 v[72:75], a[72:75], v[176:179], v[72:75]
    ds_read_b64_tr_b16 a[34:35], v28 offset:512
    ds_read_b64_tr_b16 a[36:37], v29 offset:0
    v_mfma_f32_16x16x32_bf16 v[88:91], a[72:75], v[180:183], v[88:91]
    ds_read_b64_tr_b16 a[38:39], v29 offset:512
    ds_read_b64_tr_b16 a[40:41], v30 offset:0
    v_mfma_f32_16x16x32_bf16 v[92:95], a[76:79], v[180:183], v[92:95]
    ds_read_b64_tr_b16 a[42:43], v30 offset:512
    v_mfma_f32_16x16x32_bf16 v[76:79], a[76:79], v[176:179], v[76:79]
    ds_read_b64_tr_b16 a[44:45], v31 offset:0
    ds_read_b64_tr_b16 a[46:47], v31 offset:512
    v_mfma_f32_16x16x32_bf16 v[64:67], a[80:83], v[184:187], v[64:67]
    ds_read_b64_tr_b16 a[48:49], v28 offset:4096
    v_mfma_f32_16x16x32_bf16 v[80:83], a[80:83], v[188:191], v[80:83]
    ds_read_b64_tr_b16 a[50:51], v28 offset:4608
    ds_read_b64_tr_b16 a[52:53], v29 offset:4096
    v_mfma_f32_16x16x32_bf16 v[84:87], a[84:87], v[188:191], v[84:87]
    ds_read_b64_tr_b16 a[54:55], v29 offset:4608
    ds_read_b64_tr_b16 a[56:57], v30 offset:4096
    v_mfma_f32_16x16x32_bf16 v[68:71], a[84:87], v[184:187], v[68:71]
    ds_read_b64_tr_b16 a[58:59], v30 offset:4608
    ds_read_b64_tr_b16 a[60:61], v31 offset:4096
    v_mfma_f32_16x16x32_bf16 v[72:75], a[88:91], v[184:187], v[72:75]
    ds_read_b64_tr_b16 a[62:63], v31 offset:4608
    v_mfma_f32_16x16x32_bf16 v[88:91], a[88:91], v[188:191], v[88:91]
    s_waitcnt vmcnt(22)
    v_max3_u32 v253, v192, v196, v200
    v_mfma_f32_16x16x32_bf16 v[92:95], a[92:95], v[188:191], v[92:95]
    v_max_u32 v253, v253, v204
    v_cmp_eq_u32 vcc, -1, v253
    v_mfma_f32_16x16x32_bf16 v[76:79], a[92:95], v[184:187], v[76:79]
    s_cbranch_vccnz L_ra1_11
L_ra1_11_b:
    v_mfma_f32_16x16x32_bf16 v[64:67], a[96:99], v[192:195], v[64:67]
    s_cmp_lt_u32 s58, 2
    v_mfma_f32_16x16x32_bf16 v[80:83], a[96:99], v[196:199], v[80:83]
    s_cselect_b32 s49, s50, s51
    v_mfma_f32_16x16x32_bf16 v[84:87], a[100:103], v[196:199], v[84:87]
    s_add_u32 s49, s49, 159744
    buffer_load_dwordx4 v[144:147], v17, s[40:43], s49 offen offset:0 sc1
    v_mfma_f32_16x16x32_bf16 v[68:71], a[100:103], v[192:195], v[68:71]
    ds_read_b64_tr_b16 a[64:65], v28 offset:8192
    v_mfma_f32_16x16x32_bf16 v[72:75], a[104:107], v[192:195], v[72:75]
    buffer_load_dwordx4 v241, s[24:27], s3 offen offset:1024 lds
    ds_read_b64_tr_b16 a[66:67], v28 offset:8704
    v_mfma_f32_16x16x32_bf16 v[88:91], a[104:107], v[196:199], v[88:91]
    ds_read_b64_tr_b16 a[68:69], v29 offset:8192
    v_mfma_f32_16x16x32_bf16 v[92:95], a[108:111], v[196:199], v[92:95]
    buffer_load_dwordx4 v[148:151], v18, s[40:43], s49 offen offset:0 sc1
    v_mfma_f32_16x16x32_bf16 v[76:79], a[108:111], v[192:195], v[76:79]
    ds_read_b64_tr_b16 a[70:71], v29 offset:8704
    ds_read_b64_tr_b16 a[72:73], v30 offset:8192
    v_mfma_f32_16x16x32_bf16 v[64:67], a[112:115], v[200:203], v[64:67]
    buffer_load_dwordx4 v[152:155], v17, s[40:43], s49 offen offset:2048 sc1
    v_mfma_f32_16x16x32_bf16 v[80:83], a[112:115], v[204:207], v[80:83]
    ds_read_b64_tr_b16 a[74:75], v30 offset:8704
    ds_read_b64_tr_b16 a[76:77], v31 offset:8192
    v_mfma_f32_16x16x32_bf16 v[84:87], a[116:119], v[204:207], v[84:87]
    buffer_load_dwordx4 v[156:159], v18, s[40:43], s49 offen offset:2048 sc1
    v_mfma_f32_16x16x32_bf16 v[68:71], a[116:119], v[200:203], v[68:71]
    ds_read_b64_tr_b16 a[78:79], v31 offset:8704
    v_mfma_f32_16x16x32_bf16 v[72:75], a[120:123], v[200:203], v[72:75]
    s_waitcnt vmcnt(22)
    v_max3_u32 v253, v208, v212, v216
    v_mfma_f32_16x16x32_bf16 v[88:91], a[120:123], v[204:207], v[88:91]
    v_max_u32 v253, v253, v220
    v_mfma_f32_16x16x32_bf16 v[92:95], a[124:127], v[204:207], v[92:95]
    v_cmp_eq_u32 vcc, -1, v253
    v_mfma_f32_16x16x32_bf16 v[76:79], a[124:127], v[200:203], v[76:79]
    s_cbranch_vccnz L_ra1_12
L_ra1_12_b:
    v_mfma_f32_16x16x32_bf16 v[64:67], a[128:131], v[208:211], v[64:67]
    s_load_dwordx8 s[4:11], s[40:41], s53 glc
    v_mfma_f32_16x16x32_bf16 v[80:83], a[128:131], v[212:215], v[80:83]
    buffer_load_dwordx4 v242, s[24:27], s3 offen offset:2048 lds
    v_mfma_f32_16x16x32_bf16 v[84:87], a[132:135], v[212:215], v[84:87]
    buffer_load_dwordx4 v243, s[24:27], s3 offen offset:3072 lds
    v_mfma_f32_16x16x32_bf16 v[68:71], a[132:135], v[208:211], v[68:71]
    s_waitcnt lgkmcnt(15)
    v_mfma_f32_16x16x32_bf16 v[72:75], a[136:139], v[208:211], v[72:75]
    s_cmp_lt_u32 s59, 6
    v_mfma_f32_16x16x32_bf16 v[88:91], a[136:139], v[212:215], v[88:91]
    s_cselect_b32 s3, s62, s63
    v_mfma_f32_16x16x32_bf16 v[92:95], a[140:143], v[212:215], v[92:95]
    s_add_u32 m0, s64, 20480
    v_mfma_f32_16x16x32_bf16 v[76:79], a[140:143], v[208:211], v[76:79]
    s_add_u32 s3, s3, 1048576
    v_mfma_f32_16x16x32_bf16 v[64:67], a[144:147], v[216:219], v[64:67]
    buffer_load_dwordx4 v240, s[24:27], s3 offen lds
    v_mfma_f32_16x16x32_bf16 v[80:83], a[144:147], v[220:223], v[80:83]
    buffer_load_dwordx4 v241, s[24:27], s3 offen offset:1024 lds
    v_mfma_f32_16x16x32_bf16 v[84:87], a[148:151], v[220:223], v[84:87]
    v_mfma_f32_16x16x32_bf16 v[68:71], a[148:151], v[216:219], v[68:71]
    s_waitcnt vmcnt(22)
    v_mfma_f32_16x16x32_bf16 v[72:75], a[152:155], v[216:219], v[72:75]
    v_max3_u32 v253, v224, v228, v232
    v_mfma_f32_16x16x32_bf16 v[88:91], a[152:155], v[220:223], v[88:91]
    v_max_u32 v253, v253, v236
    v_mfma_f32_16x16x32_bf16 v[92:95], a[156:159], v[220:223], v[92:95]
    v_cmp_eq_u32 vcc, -1, v253
    v_mfma_f32_16x16x32_bf16 v[76:79], a[156:159], v[216:219], v[76:79]
    s_cbranch_vccnz L_ra1_13
L_ra1_13_b:
    v_mfma_f32_16x16x32_bf16 v[64:67], a[160:163], v[224:227], v[64:67]
    buffer_load_dwordx4 v242, s[24:27], s3 offen offset:2048 lds
    v_mfma_f32_16x16x32_bf16 v[80:83], a[160:163], v[228:231], v[80:83]
    buffer_load_dwordx4 v243, s[24:27], s3 offen offset:3072 lds
    v_mfma_f32_16x16x32_bf16 v[84:87], a[164:167], v[228:231], v[84:87]
    v_mfma_f32_16x16x32_bf16 v[68:71], a[164:167], v[224:227], v[68:71]
    s_cmp_lt_u32 s59, 5
    v_mfma_f32_16x16x32_bf16 v[72:75], a[168:171], v[224:227], v[72:75]
    s_cselect_b32 s3, s62, s63
    v_mfma_f32_16x16x32_bf16 v[88:91], a[168:171], v[228:231], v[88:91]
    v_mfma_f32_16x16x32_bf16 v[92:95], a[172:175], v[228:231], v[92:95]
    s_add_u32 m0, s64, 0
    v_mfma_f32_16x16x32_bf16 v[76:79], a[172:175], v[224:227], v[76:79]
    s_add_u32 s3, s3, 1179648
    v_mfma_f32_16x16x32_bf16 v[64:67], a[176:179], v[232:235], v[64:67]
    buffer_load_dwordx4 v240, s[24:27], s3 offen lds
    v_mfma_f32_16x16x32_bf16 v[80:83], a[176:179], v[236:239], v[80:83]
    buffer_load_dwordx4 v241, s[24:27], s3 offen offset:1024 lds
    v_mfma_f32_16x16x32_bf16 v[84:87], a[180:183], v[236:239], v[84:87]
    v_mfma_f32_16x16x32_bf16 v[68:71], a[180:183], v[232:235], v[68:71]
    s_waitcnt vmcnt(22)
    v_mfma_f32_16x16x32_bf16 v[72:75], a[184:187], v[232:235], v[72:75]
    v_max3_u32 v253, v128, v132, v136
    v_mfma_f32_16x16x32_bf16 v[88:91], a[184:187], v[236:239], v[88:91]
    v_max_u32 v253, v253, v140
    v_mfma_f32_16x16x32_bf16 v[92:95], a[188:191], v[236:239], v[92:95]
    v_cmp_eq_u32 vcc, -1, v253
    v_mfma_f32_16x16x32_bf16 v[76:79], a[188:191], v[232:235], v[76:79]
    s_cbranch_vccnz L_ra1_14
L_ra1_14_b:
L_p3_c:
    s_waitcnt lgkmcnt(0)
    s_xor_b64 s[4:5], s[4:5], s[68:69]
    s_xor_b64 s[6:7], s[6:7], s[68:69]
    s_xor_b64 s[8:9], s[8:9], s[68:69]
    s_xor_b64 s[10:11], s[10:11], s[68:69]
    s_or_b64 s[4:5], s[4:5], s[6:7]
    s_or_b64 s[8:9], s[8:9], s[10:11]
    s_or_b64 s[4:5], s[4:5], s[8:9]
    s_cbranch_scc0 L_p3_ok
    s_load_dwordx8 s[4:11], s[40:41], s53 glc
    s_sub_u32 s45, s45, 1
    s_cbranch_scc0 L_p3_c
    s_mov_b32 s45, 0
    s_waitcnt lgkmcnt(0)
L_p3_ok:
    v_mfma_f32_16x16x32_bf16 v[64:67], a[192:195], v[128:131], v[64:67]
    s_cmp_lt_u32 s59, 14
    s_cselect_b32 s49, s12, s13
    v_mfma_f32_16x16x32_bf16 v[80:83], a[192:195], v[132:135], v[80:83]
    s_add_u32 s49, s49, 0
    v_mfma_f32_16x16x32_bf16 v[84:87], a[196:199], v[132:135], v[84:87]
    buffer_load_dwordx4 v[160:163], v0, s[40:43], s49 offen offset:0 sc1
    v_mfma_f32_16x16x32_bf16 v[68:71], a[196:199], v[128:131], v[68:71]
    buffer_load_dwordx4 v242, s[24:27], s3 offen offset:2048 lds
    buffer_load_dwordx4 v[164:167], v0, s[40:43], s49 offen offset:1024 sc1
    v_mfma_f32_16x16x32_bf16 v[72:75], a[200:203], v[128:131], v[72:75]
    buffer_load_dwordx4 v243, s[24:27], s3 offen offset:3072 lds
    v_mfma_f32_16x16x32_bf16 v[88:91], a[200:203], v[132:135], v[88:91]
    buffer_load_dwordx4 v[168:171], v0, s[40:43], s49 offen offset:2048 sc1
    v_mfma_f32_16x16x32_bf16 v[92:95], a[204:207], v[132:135], v[92:95]
    s_cmp_lt_u32 s59, 4
    v_mfma_f32_16x16x32_bf16 v[76:79], a[204:207], v[128:131], v[76:79]
    s_cselect_b32 s3, s62, s63
    v_mfma_f32_16x16x32_bf16 v[64:67], a[208:211], v[136:139], v[64:67]
    s_add_u32 m0, s64, 4096
    v_mfma_f32_16x16x32_bf16 v[80:83], a[208:211], v[140:143], v[80:83]
    s_add_u32 s3, s3, 1310720
    buffer_load_dwordx4 v240, s[24:27], s3 offen lds
    v_mfma_f32_16x16x32_bf16 v[84:87], a[212:215], v[140:143], v[84:87]
    buffer_load_dwordx4 v[172:175], v0, s[40:43], s49 offen offset:3072 sc1
    v_mfma_f32_16x16x32_bf16 v[68:71], a[212:215], v[136:139], v[68:71]
    buffer_load_dwordx4 v241, s[24:27], s3 offen offset:1024 lds
    v_mfma_f32_16x16x32_bf16 v[72:75], a[216:219], v[136:139], v[72:75]
    s_waitcnt vmcnt(16)
    v_max3_u32 v253, v144, v148, v152
    v_mfma_f32_16x16x32_bf16 v[88:91], a[216:219], v[140:143], v[88:91]
    v_max_u32 v253, v253, v156
    v_mfma_f32_16x16x32_bf16 v[92:95], a[220:223], v[140:143], v[92:95]
    v_cmp_eq_u32 vcc, -1, v253
    v_mfma_f32_16x16x32_bf16 v[76:79], a[220:223], v[136:139], v[76:79]
    s_cbranch_vccnz L_ra1_15
L_ra1_15_b:
    v_mfma_f32_16x16x32_bf16 v[88:91], a[232:235], v[148:151], v[88:91]
    s_cmp_lt_u32 s59, 12
    s_cselect_b32 s49, s12, s13
    s_add_u32 s49, s49, 4096
    v_mfma_f32_16x16x32_bf16 v[92:95], a[236:239], v[148:151], v[92:95]
    buffer_load_dwordx4 v[176:179], v0, s[40:43], s49 offen offset:0 sc1
    ds_read_b64_tr_b16 a[80:81], v28 offset:12288
    ds_read_b64_tr_b16 a[82:83], v28 offset:12800
    v_mfma_f32_16x16x32_bf16 v[88:91], a[248:251], v[156:159], v[88:91]
    buffer_load_dwordx4 v242, s[24:27], s3 offen offset:2048 lds
    ds_read_b64_tr_b16 a[84:85], v29 offset:12288
    ds_read_b64_tr_b16 a[86:87], v29 offset:12800
    v_mfma_f32_16x16x32_bf16 v[92:95], a[252:255], v[156:159], v[92:95]
    buffer_load_dwordx4 v[180:183], v0, s[40:43], s49 offen offset:1024 sc1
    ds_read_b64_tr_b16 a[88:89], v30 offset:12288
    ds_read_b64_tr_b16 a[90:91], v30 offset:12800
    v_mfma_f32_16x16x32_bf16 v[80:83], a[224:227], v[148:151], v[80:83]
    buffer_load_dwordx4 v243, s[24:27], s3 offen offset:3072 lds
    ds_read_b64_tr_b16 a[92:93], v31 offset:12288
    ds_read_b64_tr_b16 a[94:95], v31 offset:12800
    v_mfma_f32_16x16x32_bf16 v[84:87], a[228:231], v[148:151], v[84:87]
    buffer_load_dwordx4 v[184:187], v0, s[40:43], s49 offen offset:2048 sc1
    ds_read_b64_tr_b16 a[96:97], v244 offset:49152
    v_mfma_f32_16x16x32_bf16 v[80:83], a[240:243], v[156:159], v[80:83]
    ds_read_b64_tr_b16 a[98:99], v244 offset:49664
    s_cmp_lt_u32 s59, 3
    v_mfma_f32_16x16x32_bf16 v[84:87], a[244:247], v[156:159], v[84:87]
    s_cselect_b32 s3, s62, s63
    ds_write_b128 v11, v[88:91] offset:28672
    v_mfma_f32_16x16x32_bf16 v[72:75], a[232:235], v[144:147], v[72:75]
    s_add_u32 m0, s64, 8192
    s_add_u32 s3, s3, 1441792
    v_mfma_f32_16x16x32_bf16 v[76:79], a[236:239], v[144:147], v[76:79]
    buffer_load_dwordx4 v240, s[24:27], s3 offen lds
    ds_write_b128 v11, v[92:95] offset:29696
    v_mfma_f32_16x16x32_bf16 v[72:75], a[248:251], v[152:155], v[72:75]
    ds_read_b64_tr_b16 a[100:101], v245 offset:49152
    ds_read_b64_tr_b16 a[102:103], v245 offset:49664
    v_mfma_f32_16x16x32_bf16 v[76:79], a[252:255], v[152:155], v[76:79]
    buffer_load_dwordx4 v[188:191], v0, s[40:43], s49 offen offset:3072 sc1
    ds_write_b128 v10, v[80:83] offset:26624
    v_mfma_f32_16x16x32_bf16 v[64:67], a[224:227], v[144:147], v[64:67]
    ds_read_b64_tr_b16 a[104:105], v246 offset:49152
    ds_read_b64_tr_b16 a[106:107], v246 offset:49664
    v_mfma_f32_16x16x32_bf16 v[68:71], a[228:231], v[144:147], v[68:71]
    buffer_load_dwordx4 v241, s[24:27], s3 offen offset:1024 lds
    ds_write_b128 v10, v[84:87] offset:27648
    v_mfma_f32_16x16x32_bf16 v[64:67], a[240:243], v[152:155], v[64:67]
    ds_read_b64_tr_b16 a[108:109], v247 offset:49152
    ds_read_b64_tr_b16 a[110:111], v247 offset:49664
    v_mfma_f32_16x16x32_bf16 v[68:71], a[244:247], v[152:155], v[68:71]
    ds_write_b128 v9, v[72:75] offset:24576
    ds_write_b128 v9, v[76:79] offset:25600
    s_nop 2
    v_pk_add_f32 v[64:65], v[64:65], v[96:97]
    v_pk_add_f32 v[66:67], v[66:67], v[98:99]
    s_nop 0
    v_pk_add_f32 v[68:69], v[68:69], v[100:101]
    v_pk_add_f32 v[70:71], v[70:71], v[102:103]
    s_waitcnt lgkmcnt(0)
    s_barrier
    ds_read_b128 v[72:75], v12 offset:24576
    ds_read_b128 v[80:83], v12 offset:26624
    ds_read_b128 v[88:91], v12 offset:28672
    ds_read_b128 v[76:79], v12 offset:25600
    ds_read_b128 v[84:87], v12 offset:27648
    ds_read_b128 v[92:95], v12 offset:29696
    s_waitcnt lgkmcnt(3)
    s_cmp_lt_u32 s59, 10
    s_cselect_b32 s49, s12, s13
    s_add_u32 s49, s49, 8192
    buffer_load_dwordx4 v[192:195], v0, s[40:43], s49 offen offset:0 sc1
    v_pk_add_f32 v[72:73], v[72:73], v[80:81]
    v_pk_add_f32 v[74:75], v[74:75], v[82:83]
    v_pk_add_f32 v[64:65], v[64:65], v[88:89]
    buffer_load_dwordx4 v242, s[24:27], s3 offen offset:2048 lds
    v_pk_add_f32 v[66:67], v[66:67], v[90:91]
    s_waitcnt lgkmcnt(0)
    v_pk_add_f32 v[76:77], v[76:77], v[84:85]
    v_pk_add_f32 v[78:79], v[78:79], v[86:87]
    buffer_load_dwordx4 v[196:199], v0, s[40:43], s49 offen offset:1024 sc1
    v_pk_add_f32 v[68:69], v[68:69], v[92:93]
    v_pk_add_f32 v[70:71], v[70:71], v[94:95]
    v_pk_add_f32 v[64:65], v[64:65], v[72:73]
    v_pk_add_f32 v[66:67], v[66:67], v[74:75]
    buffer_load_dwordx4 v[200:203], v0, s[40:43], s49 offen offset:2048 sc1
    v_pk_add_f32 v[68:69], v[68:69], v[76:77]
    v_pk_add_f32 v[70:71], v[70:71], v[78:79]
    v_pk_mul_f32 v[120:121], v[64:65], v[64:65]
    v_pk_mul_f32 v[122:123], v[66:67], v[66:67]
    buffer_load_dwordx4 v243, s[24:27], s3 offen offset:3072 lds
    v_pk_mul_f32 v[124:125], v[68:69], v[68:69]
    v_pk_mul_f32 v[126:127], v[70:71], v[70:71]
    v_pk_fma_f32 v[120:121], v[120:121], v[104:105], v[104:105] op_sel:[0,0,1] op_sel_hi:[1,0,1]
    buffer_load_dwordx4 v[204:207], v0, s[40:43], s49 offen offset:3072 sc1
    v_pk_fma_f32 v[122:123], v[122:123], v[104:105], v[104:105] op_sel:[0,0,1] op_sel_hi:[1,0,1]
    v_pk_fma_f32 v[124:125], v[124:125], v[104:105], v[104:105] op_sel:[0,0,1] op_sel_hi:[1,0,1]
    v_pk_fma_f32 v[126:127], v[126:127], v[104:105], v[104:105] op_sel:[0,0,1] op_sel_hi:[1,0,1]
    v_pk_mul_f32 v[120:121], v[120:121], v[64:65]
    s_cmp_lt_u32 s59, 8
    s_cselect_b32 s49, s12, s13
    s_add_u32 s49, s49, 12288
    buffer_load_dwordx4 v[208:211], v0, s[40:43], s49 offen offset:0 sc1
    v_pk_mul_f32 v[122:123], v[122:123], v[66:67]
    v_pk_mul_f32 v[124:125], v[124:125], v[68:69]
    v_pk_mul_f32 v[126:127], v[126:127], v[70:71]
    v_exp_f32 v120, v120
    s_cmp_lt_u32 s59, 2
    s_cselect_b32 s3, s62, s63
    s_add_u32 m0, s64, 12288
    s_add_u32 s3, s3, 1572864
    buffer_load_dwordx4 v240, s[24:27], s3 offen lds
    v_exp_f32 v121, v121
    v_exp_f32 v122, v122
    v_exp_f32 v123, v123
    v_exp_f32 v124, v124
    buffer_load_dwordx4 v[212:215], v0, s[40:43], s49 offen offset:1024 sc1
    v_exp_f32 v125, v125
    v_exp_f32 v126, v126
    v_exp_f32 v127, v127
    buffer_load_dwordx4 v[216:219], v0, s[40:43], s49 offen offset:2048 sc1
    v_pk_add_f32 v[120:121], v[120:121], 1.0 op_sel_hi:[1,0]
    v_pk_add_f32 v[122:123], v[122:123], 1.0 op_sel_hi:[1,0]
    v_pk_add_f32 v[124:125], v[124:125], 1.0 op_sel_hi:[1,0]
    v_pk_add_f32 v[126:127], v[126:127], 1.0 op_sel_hi:[1,0]
    buffer_load_dwordx4 v241, s[24:27], s3 offen offset:1024 lds
    v_rcp_f32 v120, v120
    v_rcp_f32 v121, v121
    v_rcp_f32 v122, v122
    v_rcp_f32 v123, v123
    buffer_load_dwordx4 v[220:223], v0, s[40:43], s49 offen offset:3072 sc1
    v_rcp_f32 v124, v124
    v_rcp_f32 v125, v125
    v_rcp_f32 v126, v126
    v_rcp_f32 v127, v127
    v_pk_mul_f32 v[64:65], v[120:121], v[64:65]
    v_pk_mul_f32 v[66:67], v[122:123], v[66:67]
    v_pk_mul_f32 v[68:69], v[124:125], v[68:69]
    v_pk_mul_f32 v[70:71], v[126:127], v[70:71]
    v_cvt_pk_bf16_f32 v108, v64, v65
    v_cvt_pk_bf16_f32 v109, v66, v67
    v_cvt_pk_bf16_f32 v110, v68, v69
    v_cvt_pk_bf16_f32 v111, v70, v71
    buffer_store_dwordx4 v[108:111], v17, s[40:43], s14 offen sc1
    s_cmp_lg_u32 s44, 0
    s_cbranch_scc1 L_nf4
    s_mov_b32 exec_hi, 0
    buffer_store_dword v6, v7, s[40:43], s15 offen offset:64 sc1
    s_mov_b32 exec_hi, -1
L_nf4:
    buffer_load_dwordx4 v242, s[24:27], s3 offen offset:2048 lds
    buffer_load_dwordx4 v243, s[24:27], s3 offen offset:3072 lds
L_join3:
    s_waitcnt vmcnt(24)
    v_max3_u32 v253, v160, v164, v168
    v_max_u32 v253, v253, v172
    v_cmp_eq_u32 vcc, -1, v253
    s_cbranch_vccnz L_ra0_16
L_ra0_16_b:
    v_mfma_f32_16x16x32_bf16 v[32:35], v[160:163], a[0:3], 0
    s_cmp_lt_u32 s59, 6
    s_cselect_b32 s49, s12, s13
    v_mfma_f32_16x16x32_bf16 v[36:39], v[164:167], a[0:3], 0
    s_add_u32 s49, s49, 16384
    buffer_load_dwordx4 v[224:227], v0, s[40:43], s49 offen offset:0 sc1
    ds_read_b64_tr_b16 a[112:113], v28 offset:16384
    v_mfma_f32_16x16x32_bf16 v[44:47], v[164:167], a[4:7], 0
    ds_read_b64_tr_b16 a[114:115], v28 offset:16896
    v_mfma_f32_16x16x32_bf16 v[40:43], v[160:163], a[4:7], 0
    s_cmp_lt_u32 s59, 1
    s_cselect_b32 s3, s62, s63
    s_add_u32 m0, s52, 49152
    v_mfma_f32_16x16x32_bf16 v[48:51], v[160:163], a[8:11], 0
    s_add_u32 s3, s3, 1703936
    buffer_load_dwordx4 v240, s[24:27], s3 offen lds
    ds_read_b64_tr_b16 a[116:117], v29 offset:16384
    v_mfma_f32_16x16x32_bf16 v[52:55], v[164:167], a[8:11], 0
    ds_read_b64_tr_b16 a[118:119], v29 offset:16896
    buffer_load_dwordx4 v[228:231], v0, s[40:43], s49 offen offset:1024 sc1
    v_mfma_f32_16x16x32_bf16 v[60:63], v[164:167], a[12:15], 0
    ds_read_b64_tr_b16 a[120:121], v30 offset:16384
    ds_read_b64_tr_b16 a[122:123], v30 offset:16896
    buffer_load_dwordx4 v241, s[24:27], s3 offen offset:1024 lds
    v_mfma_f32_16x16x32_bf16 v[56:59], v[160:163], a[12:15], 0
    ds_read_b64_tr_b16 a[124:125], v31 offset:16384
    ds_read_b64_tr_b16 a[126:127], v31 offset:16896
    v_mfma_f32_16x16x32_bf16 v[32:35], v[168:171], a[16:19], v[32:35]
    buffer_load_dwordx4 v[232:235], v0, s[40:43], s49 offen offset:2048 sc1
    ds_read_b64_tr_b16 a[128:129], v28 offset:20480
    v_mfma_f32_16x16x32_bf16 v[36:39], v[172:175], a[16:19], v[36:39]
    ds_read_b64_tr_b16 a[130:131], v28 offset:20992
    buffer_load_dwordx4 v242, s[24:27], s3 offen offset:2048 lds
    ds_read_b64_tr_b16 a[132:133], v29 offset:20480
    v_mfma_f32_16x16x32_bf16 v[44:47], v[172:175], a[20:23], v[44:47]
    ds_read_b64_tr_b16 a[134:135], v29 offset:20992
    buffer_load_dwordx4 v[236:239], v0, s[40:43], s49 offen offset:3072 sc1
    v_mfma_f32_16x16x32_bf16 v[40:43], v[168:171], a[20:23], v[40:43]
    ds_read_b64_tr_b16 a[136:137], v30 offset:20480
    ds_read_b64_tr_b16 a[138:139], v30 offset:20992
    buffer_load_dwordx4 v243, s[24:27], s3 offen offset:3072 lds
    v_mfma_f32_16x16x32_bf16 v[48:51], v[168:171], a[24:27], v[48:51]
    ds_read_b64_tr_b16 a[140:141], v31 offset:20480
    ds_read_b64_tr_b16 a[142:143], v31 offset:20992
    v_mfma_f32_16x16x32_bf16 v[52:55], v[172:175], a[24:27], v[52:55]
    s_waitcnt vmcnt(24)
    v_max3_u32 v253, v176, v180, v184
    v_mfma_f32_16x16x32_bf16 v[60:63], v[172:175], a[28:31], v[60:63]
    v_max_u32 v253, v253, v188
    v_cmp_eq_u32 vcc, -1, v253
    v_mfma_f32_16x16x32_bf16 v[56:59], v[168:171], a[28:31], v[56:59]
    s_cbranch_vccnz L_ra0_17
L_ra0_17_b:
    v_mfma_f32_16x16x32_bf16 v[32:35], v[176:179], a[32:35], v[32:35]
    s_cmp_lt_u32 s59, 4
    v_mfma_f32_16x16x32_bf16 v[36:39], v[180:183], a[32:35], v[36:39]
    s_cselect_b32 s49, s12, s13
    s_add_u32 s49, s49, 20480
    v_mfma_f32_16x16x32_bf16 v[44:47], v[180:183], a[36:39], v[44:47]
    buffer_load_dwordx4 v[128:131], v0, s[40:43], s49 offen offset:0 sc1
    ds_read_b64_tr_b16 a[144:145], v28 offset:0
    v_mfma_f32_16x16x32_bf16 v[40:43], v[176:179], a[36:39], v[40:43]
    ds_read_b64_tr_b16 a[146:147], v28 offset:512
    ds_read_b64_tr_b16 a[148:149], v29 offset:0
    v_mfma_f32_16x16x32_bf16 v[48:51], v[176:179], a[40:43], v[48:51]
    ds_read_b64_tr_b16 a[150:151], v29 offset:512
    buffer_load_dwordx4 v[132:135], v0, s[40:43], s49 offen offset:1024 sc1
    v_mfma_f32_16x16x32_bf16 v[52:55], v[180:183], a[40:43], v[52:55]
    ds_read_b64_tr_b16 a[152:153], v30 offset:0
    ds_read_b64_tr_b16 a[154:155], v30 offset:512
    v_mfma_f32_16x16x32_bf16 v[60:63], v[180:183], a[44:47], v[60:63]
    ds_read_b64_tr_b16 a[156:157], v31 offset:0
    ds_read_b64_tr_b16 a[158:159], v31 offset:512
    v_mfma_f32_16x16x32_bf16 v[56:59], v[176:179], a[44:47], v[56:59]
    buffer_load_dwordx4 v[136:139], v0, s[40:43], s49 offen offset:2048 sc1
    v_mfma_f32_16x16x32_bf16 v[32:35], v[184:187], a[48:51], v[32:35]
    ds_read_b64_tr_b16 a[160:161], v28 offset:4096
    ds_read_b64_tr_b16 a[162:163], v28 offset:4608
    v_mfma_f32_16x16x32_bf16 v[36:39], v[188:191], a[48:51], v[36:39]
    ds_read_b64_tr_b16 a[164:165], v29 offset:4096
    ds_read_b64_tr_b16 a[166:167], v29 offset:4608
    v_mfma_f32_16x16x32_bf16 v[44:47], v[188:191], a[52:55], v[44:47]
    buffer_load_dwordx4 v[140:143], v0, s[40:43], s49 offen offset:3072 sc1
    ds_read_b64_tr_b16 a[168:169], v30 offset:4096
    v_mfma_f32_16x16x32_bf16 v[40:43], v[184:187], a[52:55], v[40:43]
    ds_read_b64_tr_b16 a[170:171], v30 offset:4608
    ds_read_b64_tr_b16 a[172:173], v31 offset:4096
    v_mfma_f32_16x16x32_bf16 v[48:51], v[184:187], a[56:59], v[48:51]
    ds_read_b64_tr_b16 a[174:175], v31 offset:4608
    v_mfma_f32_16x16x32_bf16 v[52:55], v[188:191], a[56:59], v[52:55]
    s_waitcnt vmcnt(21)
    v_max3_u32 v253, v192, v196, v200
    v_mfma_f32_16x16x32_bf16 v[60:63], v[188:191], a[60:63], v[60:63]
    v_max_u32 v253, v253, v204
    v_cmp_eq_u32 vcc, -1, v253
    v_mfma_f32_16x16x32_bf16 v[56:59], v[184:187], a[60:63], v[56:59]
    s_cbranch_vccnz L_ra0_18
L_ra0_18_b:
    v_mfma_f32_16x16x32_bf16 v[32:35], v[192:195], a[64:67], v[32:35]
    s_load_dwordx8 s[4:11], s[40:41], s53 offset:64 glc
    v_mfma_f32_16x16x32_bf16 v[36:39], v[196:199], a[64:67], v[36:39]
    v_lshlrev_b32 v26, 16, v26
    s_cmp_lt_u32 s59, 2
    v_mfma_f32_16x16x32_bf16 v[44:47], v[196:199], a[68:71], v[44:47]
    s_cselect_b32 s49, s12, s13
    v_mfma_f32_16x16x32_bf16 v[40:43], v[192:195], a[68:71], v[40:43]
    s_add_u32 s49, s49, 24576
    buffer_load_dwordx4 v[144:147], v0, s[40:43], s49 offen offset:0 sc1
    v_mfma_f32_16x16x32_bf16 v[48:51], v[192:195], a[72:75], v[48:51]
    ds_read_b64_tr_b16 a[176:177], v28 offset:8192
    v_mfma_f32_16x16x32_bf16 v[52:55], v[196:199], a[72:75], v[52:55]
    ds_read_b64_tr_b16 a[178:179], v28 offset:8704
    buffer_load_dwordx4 v[148:151], v0, s[40:43], s49 offen offset:1024 sc1
    v_mfma_f32_16x16x32_bf16 v[60:63], v[196:199], a[76:79], v[60:63]
    ds_read_b64_tr_b16 a[180:181], v29 offset:8192
    ds_read_b64_tr_b16 a[182:183], v29 offset:8704
    v_mfma_f32_16x16x32_bf16 v[56:59], v[192:195], a[76:79], v[56:59]
    v_mov_b32 v27, v26
    v_mfma_f32_16x16x32_bf16 v[32:35], v[200:203], a[80:83], v[32:35]
    buffer_load_dwordx4 v[152:155], v0, s[40:43], s49 offen offset:2048 sc1
    ds_read_b64_tr_b16 a[184:185], v30 offset:8192
    v_mfma_f32_16x16x32_bf16 v[36:39], v[204:207], a[80:83], v[36:39]
    ds_read_b64_tr_b16 a[186:187], v30 offset:8704
    v_mfma_f32_16x16x32_bf16 v[44:47], v[204:207], a[84:87], v[44:47]
    buffer_load_dwordx4 v[156:159], v0, s[40:43], s49 offen offset:3072 sc1
    ds_read_b64_tr_b16 a[188:189], v31 offset:8192
    v_mfma_f32_16x16x32_bf16 v[40:43], v[200:203], a[84:87], v[40:43]
    ds_read_b64_tr_b16 a[190:191], v31 offset:8704
    v_mfma_f32_16x16x32_bf16 v[48:51], v[200:203], a[88:91], v[48:51]
    s_waitcnt vmcnt(19)
    v_max3_u32 v253, v208, v212, v216
    v_mfma_f32_16x16x32_bf16 v[52:55], v[204:207], a[88:91], v[52:55]
    v_max_u32 v253, v253, v220
    v_mfma_f32_16x16x32_bf16 v[60:63], v[204:207], a[92:95], v[60:63]
    v_cmp_eq_u32 vcc, -1, v253
    v_mfma_f32_16x16x32_bf16 v[56:59], v[200:203], a[92:95], v[56:59]
    s_cbranch_vccnz L_ra0_19
L_ra0_19_b:
L_p4_c:
    s_waitcnt lgkmcnt(0)
    s_xor_b64 s[4:5], s[4:5], s[68:69]
    s_xor_b64 s[6:7], s[6:7], s[68:69]
    s_xor_b64 s[8:9], s[8:9], s[68:69]
    s_xor_b64 s[10:11], s[10:11], s[68:69]
    s_or_b64 s[4:5], s[4:5], s[6:7]
    s_or_b64 s[8:9], s[8:9], s[10:11]
    s_or_b64 s[4:5], s[4:5], s[8:9]
    s_cbranch_scc0 L_p4_ok
    s_load_dwordx8 s[4:11], s[40:41], s53 offset:64 glc
    s_sub_u32 s45, s45, 1
    s_cbranch_scc0 L_p4_c
    s_mov_b32 s45, 0
    s_waitcnt lgkmcnt(0)
L_p4_ok:
    v_mfma_f32_16x16x32_bf16 v[32:35], v[208:211], a[96:99], v[32:35]
    v_add_u32 v12, s64, v8
    s_cmp_lt_u32 s59, 14
    v_mfma_f32_16x16x32_bf16 v[36:39], v[212:215], a[96:99], v[36:39]
    s_cselect_b32 s49, s12, s13
    s_add_u32 s49, s49, 114688
    v_mfma_f32_16x16x32_bf16 v[44:47], v[212:215], a[100:103], v[44:47]
    buffer_load_dwordx4 v[160:163], v0, s[40:43], s49 offen offset:0 sc1
    v_mfma_f32_16x16x32_bf16 v[40:43], v[208:211], a[100:103], v[40:43]
    s_xor_b32 s47, s44, 1
    s_mul_i32 s47, s47, 24576
    v_mfma_f32_16x16x32_bf16 v[48:51], v[208:211], a[104:107], v[48:51]
    s_add_u32 s47, s47, 65536
    buffer_load_dwordx4 v[164:167], v0, s[40:43], s49 offen offset:1024 sc1
    v_mfma_f32_16x16x32_bf16 v[52:55], v[212:215], a[104:107], v[52:55]
    v_add_u32 v9, s47, v8
    v_mfma_f32_16x16x32_bf16 v[60:63], v[212:215], a[108:111], v[60:63]
    s_xor_b32 s47, s44, 2
    s_mul_i32 s47, s47, 24576
    v_mfma_f32_16x16x32_bf16 v[56:59], v[208:211], a[108:111], v[56:59]
    buffer_load_dwordx4 v[168:171], v0, s[40:43], s49 offen offset:2048 sc1
    s_add_u32 s47, s47, 65536
    v_mfma_f32_16x16x32_bf16 v[32:35], v[216:219], a[112:115], v[32:35]
    v_add_u32 v10, s47, v8
    v_mfma_f32_16x16x32_bf16 v[36:39], v[220:223], a[112:115], v[36:39]
    s_xor_b32 s47, s44, 3
    buffer_load_dwordx4 v[172:175], v0, s[40:43], s49 offen offset:3072 sc1
    v_mfma_f32_16x16x32_bf16 v[44:47], v[220:223], a[116:119], v[44:47]
    s_mul_i32 s47, s47, 24576
    s_add_u32 s47, s47, 65536
    v_mfma_f32_16x16x32_bf16 v[40:43], v[216:219], a[116:119], v[40:43]
    v_add_u32 v11, s47, v8
    v_mfma_f32_16x16x32_bf16 v[48:51], v[216:219], a[120:123], v[48:51]
    s_waitcnt vmcnt(13)
    v_max3_u32 v253, v224, v228, v232
    v_mfma_f32_16x16x32_bf16 v[52:55], v[220:223], a[120:123], v[52:55]
    v_max_u32 v253, v253, v236
    v_mfma_f32_16x16x32_bf16 v[60:63], v[220:223], a[124:127], v[60:63]
    v_cmp_eq_u32 vcc, -1, v253
    v_mfma_f32_16x16x32_bf16 v[56:59], v[216:219], a[124:127], v[56:59]
    s_cbranch_vccnz L_ra0_20
L_ra0_20_b:
    v_mfma_f32_16x16x32_bf16 v[32:35], v[224:227], a[128:131], v[32:35]
    s_cmp_lt_u32 s59, 12
    v_mfma_f32_16x16x32_bf16 v[36:39], v[228:231], a[128:131], v[36:39]
    s_cselect_b32 s49, s12, s13
    v_mfma_f32_16x16x32_bf16 v[44:47], v[228:231], a[132:135], v[44:47]
    s_add_u32 s49, s49, 118784
    v_mfma_f32_16x16x32_bf16 v[40:43], v[224:227], a[132:135], v[40:43]
    buffer_load_dwordx4 v[176:179], v0, s[40:43], s49 offen offset:0 sc1
    ds_read_b64_tr_b16 a[192:193], v28 offset:12288
    v_mfma_f32_16x16x32_bf16 v[48:51], v[224:227], a[136:139], v[48:51]
    ds_read_b64_tr_b16 a[194:195], v28 offset:12800
    v_mfma_f32_16x16x32_bf16 v[52:55], v[228:231], a[136:139], v[52:55]
    buffer_load_dwordx4 v[180:183], v0, s[40:43], s49 offen offset:1024 sc1
    v_mfma_f32_16x16x32_bf16 v[60:63], v[228:231], a[140:143], v[60:63]
    ds_read_b64_tr_b16 a[196:197], v29 offset:12288
    ds_read_b64_tr_b16 a[198:199], v29 offset:12800
    v_mfma_f32_16x16x32_bf16 v[56:59], v[224:227], a[140:143], v[56:59]
    buffer_load_dwordx4 v[184:187], v0, s[40:43], s49 offen offset:2048 sc1
    v_mfma_f32_16x16x32_bf16 v[32:35], v[232:235], a[144:147], v[32:35]
    ds_read_b64_tr_b16 a[200:201], v30 offset:12288
    v_mfma_f32_16x16x32_bf16 v[36:39], v[236:239], a[144:147], v[36:39]
    ds_read_b64_tr_b16 a[202:203], v30 offset:12800
    buffer_load_dwordx4 v[188:191], v0, s[40:43], s49 offen offset:3072 sc1
    v_mfma_f32_16x16x32_bf16 v[44:47], v[236:239], a[148:151], v[44:47]
    ds_read_b64_tr_b16 a[204:205], v31 offset:12288
    v_mfma_f32_16x16x32_bf16 v[40:43], v[232:235], a[148:151], v[40:43]
    ds_read_b64_tr_b16 a[206:207], v31 offset:12800
    v_mfma_f32_16x16x32_bf16 v[48:51], v[232:235], a[152:155], v[48:51]
    s_waitcnt vmcnt(12)
    v_max3_u32 v253, v128, v132, v136
    v_mfma_f32_16x16x32_bf16 v[52:55], v[236:239], a[152:155], v[52:55]
    v_max_u32 v253, v253, v140
    v_mfma_f32_16x16x32_bf16 v[60:63], v[236:239], a[156:159], v[60:63]
    v_cmp_eq_u32 vcc, -1, v253
    v_mfma_f32_16x16x32_bf16 v[56:59], v[232:235], a[156:159], v[56:59]
    s_cbranch_vccnz L_ra0_21
L_ra0_21_b:
    v_mfma_f32_16x16x32_bf16 v[32:35], v[128:131], a[160:163], v[32:35]
    s_cmp_lt_u32 s59, 10
    v_mfma_f32_16x16x32_bf16 v[36:39], v[132:135], a[160:163], v[36:39]
    s_cselect_b32 s49, s12, s13
    v_mfma_f32_16x16x32_bf16 v[44:47], v[132:135], a[164:167], v[44:47]
    s_add_u32 s49, s49, 122880
    v_mfma_f32_16x16x32_bf16 v[40:43], v[128:131], a[164:167], v[40:43]
    buffer_load_dwordx4 v[192:195], v0, s[40:43], s49 offen offset:0 sc1
    ds_read_b64_tr_b16 a[208:209], v244 offset:49152
    v_mfma_f32_16x16x32_bf16 v[48:51], v[128:131], a[168:171], v[48:51]
    ds_read_b64_tr_b16 a[210:211], v244 offset:49664
    v_mfma_f32_16x16x32_bf16 v[52:55], v[132:135], a[168:171], v[52:55]
    buffer_load_dwordx4 v[196:199], v0, s[40:43], s49 offen offset:1024 sc1
    v_mfma_f32_16x16x32_bf16 v[60:63], v[132:135], a[172:175], v[60:63]
    ds_read_b64_tr_b16 a[212:213], v245 offset:49152
    ds_read_b64_tr_b16 a[214:215], v245 offset:49664
    v_mfma_f32_16x16x32_bf16 v[56:59], v[128:131], a[172:175], v[56:59]
    buffer_load_dwordx4 v[200:203], v0, s[40:43], s49 offen offset:2048 sc1
    v_mfma_f32_16x16x32_bf16 v[32:35], v[136:139], a[176:179], v[32:35]
    ds_read_b64_tr_b16 a[216:217], v246 offset:49152
    v_mfma_f32_16x16x32_bf16 v[36:39], v[140:143], a[176:179], v[36:39]
    ds_read_b64_tr_b16 a[218:219], v246 offset:49664
    buffer_load_dwordx4 v[204:207], v0, s[40:43], s49 offen offset:3072 sc1
    v_mfma_f32_16x16x32_bf16 v[44:47], v[140:143], a[180:183], v[44:47]
    ds_read_b64_tr_b16 a[220:221], v247 offset:49152
    v_mfma_f32_16x16x32_bf16 v[40:43], v[136:139], a[180:183], v[40:43]
    ds_read_b64_tr_b16 a[222:223], v247 offset:49664
    v_mfma_f32_16x16x32_bf16 v[48:51], v[136:139], a[184:187], v[48:51]
    s_waitcnt vmcnt(12)
    v_max3_u32 v253, v144, v148, v152
    v_mfma_f32_16x16x32_bf16 v[52:55], v[140:143], a[184:187], v[52:55]
    v_max_u32 v253, v253, v156
    v_mfma_f32_16x16x32_bf16 v[60:63], v[140:143], a[188:191], v[60:63]
    v_cmp_eq_u32 vcc, -1, v253
    v_mfma_f32_16x16x32_bf16 v[56:59], v[136:139], a[188:191], v[56:59]
    s_cbranch_vccnz L_ra0_22
L_ra0_22_b:
    s_waitcnt lgkmcnt(0)
    v_mfma_f32_16x16x32_bf16 v[32:35], v[144:147], a[192:195], v[32:35]
    s_cmp_lt_u32 s59, 8
    v_mfma_f32_16x16x32_bf16 v[36:39], v[148:151], a[192:195], v[36:39]
    s_cselect_b32 s49, s12, s13
    v_mfma_f32_16x16x32_bf16 v[44:47], v[148:151], a[196:199], v[44:47]
    s_add_u32 s49, s49, 126976
    v_mfma_f32_16x16x32_bf16 v[40:43], v[144:147], a[196:199], v[40:43]
    buffer_load_dwordx4 v[208:211], v0, s[40:43], s49 offen offset:0 sc1
    v_mfma_f32_16x16x32_bf16 v[48:51], v[144:147], a[200:203], v[48:51]
    buffer_load_dwordx2 v[112:113], v13, s[40:43], s17 offen offset:0 sc1
    v_mfma_f32_16x16x32_bf16 v[52:55], v[148:151], a[200:203], v[52:55]
    buffer_load_dwordx4 v[212:215], v0, s[40:43], s49 offen offset:1024 sc1
    v_mfma_f32_16x16x32_bf16 v[60:63], v[148:151], a[204:207], v[60:63]
    buffer_load_dwordx2 v[114:115], v13, s[40:43], s17 offen offset:1024 sc1
    v_mfma_f32_16x16x32_bf16 v[56:59], v[144:147], a[204:207], v[56:59]
    buffer_load_dwordx4 v[216:219], v0, s[40:43], s49 offen offset:2048 sc1
    v_mfma_f32_16x16x32_bf16 v[32:35], v[152:155], a[208:211], v[32:35]
    buffer_load_dwordx2 v[116:117], v13, s[40:43], s17 offen offset:2048 sc1
    v_mfma_f32_16x16x32_bf16 v[36:39], v[156:159], a[208:211], v[36:39]
    buffer_load_dwordx4 v[220:223], v0, s[40:43], s49 offen offset:3072 sc1
    v_mfma_f32_16x16x32_bf16 v[44:47], v[156:159], a[212:215], v[44:47]
    buffer_load_dwordx2 v[118:119], v13, s[40:43], s17 offen offset:3072 sc1
    v_mfma_f32_16x16x32_bf16 v[40:43], v[152:155], a[212:215], v[40:43]
    s_waitcnt vmcnt(16)
    v_mfma_f32_16x16x32_bf16 v[48:51], v[152:155], a[216:219], v[48:51]
    v_max3_u32 v253, v160, v164, v168
    v_mfma_f32_16x16x32_bf16 v[52:55], v[156:159], a[216:219], v[52:55]
    v_max_u32 v253, v253, v172
    v_mfma_f32_16x16x32_bf16 v[60:63], v[156:159], a[220:223], v[60:63]
    v_cmp_eq_u32 vcc, -1, v253
    v_mfma_f32_16x16x32_bf16 v[56:59], v[152:155], a[220:223], v[56:59]
    s_cbranch_vccnz L_ra0_23
L_ra0_23_b:
    v_mfma_f32_16x16x32_bf16 v[64:67], v[160:163], a[0:3], 0
    s_cmp_lt_u32 s59, 6
    v_mfma_f32_16x16x32_bf16 v[68:71], v[164:167], a[0:3], 0
    s_cselect_b32 s49, s12, s13
    v_mfma_f32_16x16x32_bf16 v[76:79], v[164:167], a[4:7], 0
    v_mfma_f32_16x16x32_bf16 v[72:75], v[160:163], a[4:7], 0
    s_add_u32 s49, s49, 131072
    v_mfma_f32_16x16x32_bf16 v[80:83], v[160:163], a[8:11], 0
    buffer_load_dwordx4 v[224:227], v0, s[40:43], s49 offen offset:0 sc1
    v_mfma_f32_16x16x32_bf16 v[84:87], v[164:167], a[8:11], 0
    v_mfma_f32_16x16x32_bf16 v[92:95], v[164:167], a[12:15], 0
    buffer_load_dwordx4 v[228:231], v0, s[40:43], s49 offen offset:1024 sc1
    v_mfma_f32_16x16x32_bf16 v[88:91], v[160:163], a[12:15], 0
    buffer_load_dwordx4 v[232:235], v0, s[40:43], s49 offen offset:2048 sc1
    v_mfma_f32_16x16x32_bf16 v[64:67], v[168:171], a[16:19], v[64:67]
    v_mfma_f32_16x16x32_bf16 v[68:71], v[172:175], a[16:19], v[68:71]
    buffer_load_dwordx4 v[236:239], v0, s[40:43], s49 offen offset:3072 sc1
    v_mfma_f32_16x16x32_bf16 v[76:79], v[172:175], a[20:23], v[76:79]
    v_mfma_f32_16x16x32_bf16 v[72:75], v[168:171], a[20:23], v[72:75]
    s_waitcnt vmcnt(16)
    v_mfma_f32_16x16x32_bf16 v[80:83], v[168:171], a[24:27], v[80:83]
    v_max3_u32 v253, v176, v180, v184
    v_mfma_f32_16x16x32_bf16 v[84:87], v[172:175], a[24:27], v[84:87]
    v_max_u32 v253, v253, v188
    v_mfma_f32_16x16x32_bf16 v[92:95], v[172:175], a[28:31], v[92:95]
    v_cmp_eq_u32 vcc, -1, v253
    v_mfma_f32_16x16x32_bf16 v[88:91], v[168:171], a[28:31], v[88:91]
    s_cbranch_vccnz L_ra0_24
L_ra0_24_b:
    v_mfma_f32_16x16x32_bf16 v[64:67], v[176:179], a[32:35], v[64:67]
    s_cmp_lt_u32 s59, 4
    v_mfma_f32_16x16x32_bf16 v[68:71], v[180:183], a[32:35], v[68:71]
    s_cselect_b32 s49, s12, s13
    v_mfma_f32_16x16x32_bf16 v[76:79], v[180:183], a[36:39], v[76:79]
    v_mfma_f32_16x16x32_bf16 v[72:75], v[176:179], a[36:39], v[72:75]
    s_add_u32 s49, s49, 135168
    v_mfma_f32_16x16x32_bf16 v[80:83], v[176:179], a[40:43], v[80:83]
    buffer_load_dwordx4 v[128:131], v0, s[40:43], s49 offen offset:0 sc1
    v_mfma_f32_16x16x32_bf16 v[84:87], v[180:183], a[40:43], v[84:87]
    v_mfma_f32_16x16x32_bf16 v[92:95], v[180:183], a[44:47], v[92:95]
    buffer_load_dwordx4 v[132:135], v0, s[40:43], s49 offen offset:1024 sc1
    v_mfma_f32_16x16x32_bf16 v[88:91], v[176:179], a[44:47], v[88:91]
    buffer_load_dwordx4 v[136:139], v0, s[40:43], s49 offen offset:2048 sc1
    v_mfma_f32_16x16x32_bf16 v[64:67], v[184:187], a[48:51], v[64:67]
    v_mfma_f32_16x16x32_bf16 v[68:71], v[188:191], a[48:51], v[68:71]
    buffer_load_dwordx4 v[140:143], v0, s[40:43], s49 offen offset:3072 sc1
    v_mfma_f32_16x16x32_bf16 v[76:79], v[188:191], a[52:55], v[76:79]
    v_mfma_f32_16x16x32_bf16 v[72:75], v[184:187], a[52:55], v[72:75]
    s_waitcnt vmcnt(16)
    v_mfma_f32_16x16x32_bf16 v[80:83], v[184:187], a[56:59], v[80:83]
    v_max3_u32 v253, v192, v196, v200
    v_mfma_f32_16x16x32_bf16 v[84:87], v[188:191], a[56:59], v[84:87]
    v_max_u32 v253, v253, v204
    v_mfma_f32_16x16x32_bf16 v[92:95], v[188:191], a[60:63], v[92:95]
    v_cmp_eq_u32 vcc, -1, v253
    v_mfma_f32_16x16x32_bf16 v[88:91], v[184:187], a[60:63], v[88:91]
    s_cbranch_vccnz L_ra0_25
L_ra0_25_b:
    v_mfma_f32_16x16x32_bf16 v[64:67], v[192:195], a[64:67], v[64:67]
    s_cmp_lt_u32 s59, 2
    v_mfma_f32_16x16x32_bf16 v[68:71], v[196:199], a[64:67], v[68:71]
    s_cselect_b32 s49, s12, s13
    v_mfma_f32_16x16x32_bf16 v[76:79], v[196:199], a[68:71], v[76:79]
    s_add_u32 s49, s49, 139264
    v_mfma_f32_16x16x32_bf16 v[72:75], v[192:195], a[68:71], v[72:75]
    buffer_load_dwordx4 v[144:147], v0, s[40:43], s49 offen offset:0 sc1
    v_mfma_f32_16x16x32_bf16 v[80:83], v[192:195], a[72:75], v[80:83]
    ds_write_b128 v12, v[56:59] offset:4096
    v_mfma_f32_16x16x32_bf16 v[84:87], v[196:199], a[72:75], v[84:87]
    v_mfma_f32_16x16x32_bf16 v[92:95], v[196:199], a[76:79], v[92:95]
    buffer_load_dwordx4 v[148:151], v0, s[40:43], s49 offen offset:1024 sc1
    v_mfma_f32_16x16x32_bf16 v[88:91], v[192:195], a[76:79], v[88:91]
    buffer_load_dwordx4 v[152:155], v0, s[40:43], s49 offen offset:2048 sc1
    v_mfma_f32_16x16x32_bf16 v[64:67], v[200:203], a[80:83], v[64:67]
    ds_write_b128 v12, v[60:63] offset:5120
    v_mfma_f32_16x16x32_bf16 v[68:71], v[204:207], a[80:83], v[68:71]
    buffer_load_dwordx4 v[156:159], v0, s[40:43], s49 offen offset:3072 sc1
    v_mfma_f32_16x16x32_bf16 v[76:79], v[204:207], a[84:87], v[76:79]
    v_mfma_f32_16x16x32_bf16 v[72:75], v[200:203], a[84:87], v[72:75]
    s_waitcnt vmcnt(13)
    v_mfma_f32_16x16x32_bf16 v[80:83], v[200:203], a[88:91], v[80:83]
    v_max3_u32 v253, v208, v212, v216
    v_mfma_f32_16x16x32_bf16 v[84:87], v[204:207], a[88:91], v[84:87]
    v_max_u32 v253, v253, v220
    v_mfma_f32_16x16x32_bf16 v[92:95], v[204:207], a[92:95], v[92:95]
    v_cmp_eq_u32 vcc, -1, v253
    v_mfma_f32_16x16x32_bf16 v[88:91], v[200:203], a[92:95], v[88:91]
    s_cbranch_vccnz L_ra0_26
L_ra0_26_b:
    v_mfma_f32_16x16x32_bf16 v[64:67], v[208:211], a[96:99], v[64:67]
    ds_write_b128 v12, v[48:51] offset:2048
    v_mfma_f32_16x16x32_bf16 v[68:71], v[212:215], a[96:99], v[68:71]
    v_mfma_f32_16x16x32_bf16 v[76:79], v[212:215], a[100:103], v[76:79]
    v_mfma_f32_16x16x32_bf16 v[72:75], v[208:211], a[100:103], v[72:75]
    v_mfma_f32_16x16x32_bf16 v[80:83], v[208:211], a[104:107], v[80:83]
    v_mfma_f32_16x16x32_bf16 v[84:87], v[212:215], a[104:107], v[84:87]
    ds_write_b128 v12, v[52:55] offset:3072
    v_mfma_f32_16x16x32_bf16 v[92:95], v[212:215], a[108:111], v[92:95]
    v_mfma_f32_16x16x32_bf16 v[88:91], v[208:211], a[108:111], v[88:91]
    v_mfma_f32_16x16x32_bf16 v[64:67], v[216:219], a[112:115], v[64:67]
    v_mfma_f32_16x16x32_bf16 v[68:71], v[220:223], a[112:115], v[68:71]
    v_mfma_f32_16x16x32_bf16 v[76:79], v[220:223], a[116:119], v[76:79]
    v_mfma_f32_16x16x32_bf16 v[72:75], v[216:219], a[116:119], v[72:75]
    s_waitcnt vmcnt(8)
    v_mfma_f32_16x16x32_bf16 v[80:83], v[216:219], a[120:123], v[80:83]
    v_max3_u32 v253, v224, v228, v232
    v_mfma_f32_16x16x32_bf16 v[84:87], v[220:223], a[120:123], v[84:87]
    v_max_u32 v253, v253, v236
    v_mfma_f32_16x16x32_bf16 v[92:95], v[220:223], a[124:127], v[92:95]
    v_cmp_eq_u32 vcc, -1, v253
    v_mfma_f32_16x16x32_bf16 v[88:91], v[216:219], a[124:127], v[88:91]
    s_cbranch_vccnz L_ra0_27
L_ra0_27_b:
    v_mfma_f32_16x16x32_bf16 v[64:67], v[224:227], a[128:131], v[64:67]
    v_mfma_f32_16x16x32_bf16 v[68:71], v[228:231], a[128:131], v[68:71]
    v_mfma_f32_16x16x32_bf16 v[76:79], v[228:231], a[132:135], v[76:79]
    v_mfma_f32_16x16x16_bf16 v[32:35], v[112:113], v[24:25], v[32:35]
    v_mfma_f32_16x16x32_bf16 v[72:75], v[224:227], a[132:135], v[72:75]
    v_mfma_f32_16x16x32_bf16 v[80:83], v[224:227], a[136:139], v[80:83]
    v_mfma_f32_16x16x16_bf16 v[36:39], v[114:115], v[24:25], v[36:39]
    v_mfma_f32_16x16x32_bf16 v[84:87], v[228:231], a[136:139], v[84:87]
    v_mfma_f32_16x16x32_bf16 v[92:95], v[228:231], a[140:143], v[92:95]
    ds_write_b128 v12, v[40:43] offset:0
    v_mfma_f32_16x16x32_bf16 v[88:91], v[224:227], a[140:143], v[88:91]
    v_mfma_f32_16x16x32_bf16 v[64:67], v[232:235], a[144:147], v[64:67]
    ds_write_b128 v12, v[44:47] offset:1024
    v_mfma_f32_16x16x32_bf16 v[68:71], v[236:239], a[144:147], v[68:71]
    v_mfma_f32_16x16x32_bf16 v[76:79], v[236:239], a[148:151], v[76:79]
    v_mfma_f32_16x16x32_bf16 v[72:75], v[232:235], a[148:151], v[72:75]
    s_waitcnt vmcnt(4)
    v_mfma_f32_16x16x32_bf16 v[80:83], v[232:235], a[152:155], v[80:83]
    v_max3_u32 v253, v128, v132, v136
    v_mfma_f32_16x16x32_bf16 v[84:87], v[236:239], a[152:155], v[84:87]
    v_max_u32 v253, v253, v140
    v_mfma_f32_16x16x32_bf16 v[92:95], v[236:239], a[156:159], v[92:95]
    v_cmp_eq_u32 vcc, -1, v253
    v_mfma_f32_16x16x32_bf16 v[88:91], v[232:235], a[156:159], v[88:91]
    s_cbranch_vccnz L_ra0_28
L_ra0_28_b:
    v_mfma_f32_16x16x32_bf16 v[64:67], v[128:131], a[160:163], v[64:67]
    v_mfma_f32_16x16x32_bf16 v[68:71], v[132:135], a[160:163], v[68:71]
    s_nop 4
    v_mfma_f32_16x16x16_bf16 v[64:67], v[116:117], v[24:25], v[64:67]
    v_mfma_f32_16x16x32_bf16 v[76:79], v[132:135], a[164:167], v[76:79]
    v_mfma_f32_16x16x16_bf16 v[68:71], v[118:119], v[24:25], v[68:71]
    v_mfma_f32_16x16x32_bf16 v[72:75], v[128:131], a[164:167], v[72:75]
    v_add_f32 v32, v32, v26
    v_mfma_f32_16x16x32_bf16 v[80:83], v[128:131], a[168:171], v[80:83]
    v_add_f32 v33, v33, v27
    v_mfma_f32_16x16x32_bf16 v[84:87], v[132:135], a[168:171], v[84:87]
    v_add_f32 v34, v34, v26
    v_mfma_f32_16x16x32_bf16 v[92:95], v[132:135], a[172:175], v[92:95]
    v_add_f32 v35, v35, v27
    v_mfma_f32_16x16x32_bf16 v[88:91], v[128:131], a[172:175], v[88:91]
    v_add_f32 v36, v36, v26
    v_mfma_f32_16x16x32_bf16 v[64:67], v[136:139], a[176:179], v[64:67]
    v_add_f32 v37, v37, v27
    v_mfma_f32_16x16x32_bf16 v[68:71], v[140:143], a[176:179], v[68:71]
    v_add_f32 v38, v38, v26
    v_mfma_f32_16x16x32_bf16 v[76:79], v[140:143], a[180:183], v[76:79]
    v_add_f32 v39, v39, v27
    v_mfma_f32_16x16x32_bf16 v[72:75], v[136:139], a[180:183], v[72:75]
    s_waitcnt vmcnt(0)
    v_mfma_f32_16x16x32_bf16 v[80:83], v[136:139], a[184:187], v[80:83]
    v_max3_u32 v253, v144, v148, v152
    v_mfma_f32_16x16x32_bf16 v[84:87], v[140:143], a[184:187], v[84:87]
    v_max_u32 v253, v253, v156
    v_mfma_f32_16x16x32_bf16 v[92:95], v[140:143], a[188:191], v[92:95]
    v_cmp_eq_u32 vcc, -1, v253
    v_mfma_f32_16x16x32_bf16 v[88:91], v[136:139], a[188:191], v[88:91]
    s_cbranch_vccnz L_ra0_29
L_ra0_29_b:
    v_mfma_f32_16x16x32_bf16 v[92:95], v[148:151], a[204:207], v[92:95]
    v_mfma_f32_16x16x32_bf16 v[88:91], v[144:147], a[204:207], v[88:91]
    v_mfma_f32_16x16x32_bf16 v[92:95], v[156:159], a[220:223], v[92:95]
    v_mfma_f32_16x16x32_bf16 v[88:91], v[152:155], a[220:223], v[88:91]
    v_mfma_f32_16x16x32_bf16 v[80:83], v[144:147], a[200:203], v[80:83]
    v_mfma_f32_16x16x32_bf16 v[84:87], v[148:151], a[200:203], v[84:87]
    v_mfma_f32_16x16x32_bf16 v[80:83], v[152:155], a[216:219], v[80:83]
    v_mfma_f32_16x16x32_bf16 v[84:87], v[156:159], a[216:219], v[84:87]
    s_nop 3
    ds_write_b128 v12, v[88:91] offset:10240
    v_mfma_f32_16x16x32_bf16 v[76:79], v[148:151], a[196:199], v[76:79]
    v_mfma_f32_16x16x32_bf16 v[72:75], v[144:147], a[196:199], v[72:75]
    ds_write_b128 v12, v[92:95] offset:11264
    v_mfma_f32_16x16x32_bf16 v[76:79], v[156:159], a[212:215], v[76:79]
    v_mfma_f32_16x16x32_bf16 v[72:75], v[152:155], a[212:215], v[72:75]
    ds_write_b128 v12, v[80:83] offset:8192
    v_mfma_f32_16x16x32_bf16 v[64:67], v[144:147], a[192:195], v[64:67]
    v_mfma_f32_16x16x32_bf16 v[68:71], v[148:151], a[192:195], v[68:71]
    ds_write_b128 v12, v[84:87] offset:9216
    v_mfma_f32_16x16x32_bf16 v[64:67], v[152:155], a[208:211], v[64:67]
    v_mfma_f32_16x16x32_bf16 v[68:71], v[156:159], a[208:211], v[68:71]
    s_nop 1
    ds_write_b128 v12, v[72:75] offset:6144
    ds_write_b128 v12, v[76:79] offset:7168
    s_nop 2
    v_pk_add_f32 v[64:65], v[64:65], v[26:27]
    v_pk_add_f32 v[66:67], v[66:67], v[26:27]
    v_pk_add_f32 v[68:69], v[68:69], v[26:27]
    v_pk_add_f32 v[70:71], v[70:71], v[26:27]
    s_waitcnt lgkmcnt(0)
    s_barrier
    ds_read_b128 v[40:43], v9 offset:0
    ds_read_b128 v[48:51], v10 offset:2048
    ds_read_b128 v[56:59], v11 offset:4096
    ds_read_b128 v[44:47], v9 offset:1024
    ds_read_b128 v[52:55], v10 offset:3072
    ds_read_b128 v[60:63], v11 offset:5120
    ds_read_b128 v[72:75], v9 offset:6144
    ds_read_b128 v[80:83], v10 offset:8192
    ds_read_b128 v[88:91], v11 offset:10240
    ds_read_b128 v[76:79], v9 offset:7168
    ds_read_b128 v[84:87], v10 offset:9216
    ds_read_b128 v[92:95], v11 offset:11264
    s_waitcnt lgkmcnt(9)
    v_pk_add_f32 v[40:41], v[40:41], v[48:49]
    v_pk_add_f32 v[42:43], v[42:43], v[50:51]
    v_pk_add_f32 v[32:33], v[32:33], v[56:57]
    v_pk_add_f32 v[34:35], v[34:35], v[58:59]
    s_waitcnt lgkmcnt(6)
    v_pk_add_f32 v[44:45], v[44:45], v[52:53]
    v_pk_add_f32 v[46:47], v[46:47], v[54:55]
    v_pk_add_f32 v[36:37], v[36:37], v[60:61]
    v_pk_add_f32 v[38:39], v[38:39], v[62:63]
    v_pk_add_f32 v[32:33], v[32:33], v[40:41]
    v_pk_add_f32 v[34:35], v[34:35], v[42:43]
    v_pk_add_f32 v[36:37], v[36:37], v[44:45]
    v_pk_add_f32 v[38:39], v[38:39], v[46:47]
    v_cvt_pk_bf16_f32 v120, v32, v33
    v_cvt_pk_bf16_f32 v121, v34, v35
    v_cvt_pk_bf16_f32 v122, v36, v37
    v_cvt_pk_bf16_f32 v123, v38, v39
    s_nop 0
    v_permlane16_swap_b32 v120, v122
    v_permlane16_swap_b32 v121, v123
    buffer_store_dwordx4 v[120:123], v14, s[32:35], s16 offen offset:0 sc1
    s_waitcnt lgkmcnt(3)
    v_pk_add_f32 v[72:73], v[72:73], v[80:81]
    v_pk_add_f32 v[74:75], v[74:75], v[82:83]
    v_pk_add_f32 v[64:65], v[64:65], v[88:89]
    v_pk_add_f32 v[66:67], v[66:67], v[90:91]
    s_waitcnt lgkmcnt(0)
    v_pk_add_f32 v[76:77], v[76:77], v[84:85]
    v_pk_add_f32 v[78:79], v[78:79], v[86:87]
    v_pk_add_f32 v[68:69], v[68:69], v[92:93]
    v_pk_add_f32 v[70:71], v[70:71], v[94:95]
    v_pk_add_f32 v[64:65], v[64:65], v[72:73]
    v_pk_add_f32 v[66:67], v[66:67], v[74:75]
    v_pk_add_f32 v[68:69], v[68:69], v[76:77]
    v_pk_add_f32 v[70:71], v[70:71], v[78:79]
    v_cvt_pk_bf16_f32 v108, v64, v65
    v_cvt_pk_bf16_f32 v109, v66, v67
    v_cvt_pk_bf16_f32 v110, v68, v69
    v_cvt_pk_bf16_f32 v111, v70, v71
    s_nop 0
    v_permlane16_swap_b32 v108, v110
    v_permlane16_swap_b32 v109, v111
    buffer_store_dwordx4 v[108:111], v14, s[32:35], s16 offen offset:64 sc1
L_end:
    s_endpgm
L_skip3:
    s_lshl_b32 s15, s55, 7
    s_bfe_u32 s47, s2, 131073
    s_add_u32 s15, s15, s47
    s_lshl_b32 s15, s15, 5
    s_add_u32 s15, s15, s67
    s_lshl_b32 s15, s15, 2
    s_add_u32 s15, s15, 0x880000
    s_sleep 8
    v_mov_b32 v128, -1
    v_mov_b32 v129, -1
    v_mov_b32 v130, -1
    v_mov_b32 v131, -1
    s_lshr_b32 s49, s44, 1
    s_lshl1_add_u32 s46, s100, s49
    s_mul_i32 s46, s46, 28
    s_add_u32 s46, s46, s56
    s_lshl_b32 s46, s46, 12
    s_bitcmp1_b32 s44, 0
    s_cselect_b32 s49, 14336, 0
    s_add_u32 s46, s46, s49
    s_add_u32 s46, s46, 0x5fd000
    buffer_store_dwordx4 v[128:131], v0, s[40:43], s46 offen offset:0 sc1
    buffer_store_dwordx4 v[128:131], v0, s[40:43], s46 offen offset:1024 sc1
    buffer_store_dwordx4 v[128:131], v0, s[40:43], s46 offen offset:2048 sc1
    buffer_store_dwordx4 v[128:131], v0, s[40:43], s46 offen offset:3072 sc1
    s_add_u32 s46, s46, 4096
    buffer_store_dwordx4 v[128:131], v0, s[40:43], s46 offen offset:0 sc1
    buffer_store_dwordx4 v[128:131], v0, s[40:43], s46 offen offset:1024 sc1
    buffer_store_dwordx4 v[128:131], v0, s[40:43], s46 offen offset:2048 sc1
    buffer_store_dwordx4 v[128:131], v0, s[40:43], s46 offen offset:3072 sc1
    s_add_u32 s46, s46, 4096
    buffer_store_dwordx4 v[128:131], v0, s[40:43], s46 offen offset:0 sc1
    buffer_store_dwordx4 v[128:131], v0, s[40:43], s46 offen offset:1024 sc1
    buffer_store_dwordx4 v[128:131], v0, s[40:43], s46 offen offset:2048 sc1
    buffer_store_dwordx4 v[128:131], v0, s[40:43], s46 offen offset:3072 sc1
    s_add_u32 s46, s46, 4096
    buffer_store_dwordx4 v[128:131], v0, s[40:43], s46 offen offset:0 sc1
    buffer_store_dwordx4 v[128:131], v0, s[40:43], s46 offen offset:1024 sc1
L_uc0:
    s_waitcnt vmcnt(0) lgkmcnt(0)
    s_barrier
    s_cmp_lg_u32 s44, 0
    s_cbranch_scc1 L_nf5
    s_mov_b32 exec_hi, 0
    buffer_store_dword v6, v7, s[40:43], s15 offen offset:0 sc1
    buffer_store_dword v6, v7, s[40:43], s15 offen offset:64 sc1
    s_mov_b32 exec_hi, -1
L_nf5:
    s_waitcnt lgkmcnt(0)
    s_sub_u32 s46, s64, s52
    v_subrev_u32 v244, s46, v28
    v_subrev_u32 v245, s46, v29
    v_subrev_u32 v246, s46, v30
    v_subrev_u32 v247, s46, v31
    s_cmp_lt_u32 s59, 14
    s_cselect_b32 s3, s62, s63
    s_add_u32 m0, s64, 16384
    s_add_u32 s3, s3, 0
    buffer_load_dwordx4 v240, s[24:27], s3 offen lds
    buffer_load_dwordx4 v241, s[24:27], s3 offen offset:1024 lds
    buffer_load_dwordx4 v242, s[24:27], s3 offen offset:2048 lds
    buffer_load_dwordx4 v243, s[24:27], s3 offen offset:3072 lds
    s_cmp_lt_u32 s59, 13
    s_cselect_b32 s3, s62, s63
    s_add_u32 m0, s64, 20480
    s_add_u32 s3, s3, 131072
    buffer_load_dwordx4 v240, s[24:27], s3 offen lds
    buffer_load_dwordx4 v241, s[24:27], s3 offen offset:1024 lds
    buffer_load_dwordx4 v242, s[24:27], s3 offen offset:2048 lds
    buffer_load_dwordx4 v243, s[24:27], s3 offen offset:3072 lds
    s_cmp_lt_u32 s59, 12
    s_cselect_b32 s3, s62, s63
    s_add_u32 m0, s64, 0
    s_add_u32 s3, s3, 262144
    buffer_load_dwordx4 v240, s[24:27], s3 offen lds
    buffer_load_dwordx4 v241, s[24:27], s3 offen offset:1024 lds
    buffer_load_dwordx4 v242, s[24:27], s3 offen offset:2048 lds
    buffer_load_dwordx4 v243, s[24:27], s3 offen offset:3072 lds
    s_cmp_lt_u32 s59, 11
    s_cselect_b32 s3, s62, s63
    s_add_u32 m0, s64, 4096
    s_add_u32 s3, s3, 393216
    buffer_load_dwordx4 v240, s[24:27], s3 offen lds
    buffer_load_dwordx4 v241, s[24:27], s3 offen offset:1024 lds
    buffer_load_dwordx4 v242, s[24:27], s3 offen offset:2048 lds
    buffer_load_dwordx4 v243, s[24:27], s3 offen offset:3072 lds
    s_cmp_lt_u32 s59, 10
    s_cselect_b32 s3, s62, s63
    s_add_u32 m0, s64, 8192
    s_add_u32 s3, s3, 524288
    buffer_load_dwordx4 v240, s[24:27], s3 offen lds
    buffer_load_dwordx4 v241, s[24:27], s3 offen offset:1024 lds
    buffer_load_dwordx4 v242, s[24:27], s3 offen offset:2048 lds
    buffer_load_dwordx4 v243, s[24:27], s3 offen offset:3072 lds
    s_cmp_lt_u32 s59, 9
    s_cselect_b32 s3, s62, s63
    s_add_u32 m0, s64, 12288
    s_add_u32 s3, s3, 655360
    buffer_load_dwordx4 v240, s[24:27], s3 offen lds
    buffer_load_dwordx4 v241, s[24:27], s3 offen offset:1024 lds
    buffer_load_dwordx4 v242, s[24:27], s3 offen offset:2048 lds
    buffer_load_dwordx4 v243, s[24:27], s3 offen offset:3072 lds
    s_cmp_lt_u32 s59, 8
    s_cselect_b32 s3, s62, s63
    s_add_u32 m0, s52, 49152
    s_add_u32 s3, s3, 786432
    buffer_load_dwordx4 v240, s[24:27], s3 offen lds
    buffer_load_dwordx4 v241, s[24:27], s3 offen offset:1024 lds
    buffer_load_dwordx4 v242, s[24:27], s3 offen offset:2048 lds
    buffer_load_dwordx4 v243, s[24:27], s3 offen offset:3072 lds
    s_waitcnt vmcnt(24)
    ds_read_b64_tr_b16 a[0:1], v28 offset:16384
    ds_read_b64_tr_b16 a[2:3], v28 offset:16896
    ds_read_b64_tr_b16 a[4:5], v29 offset:16384
    ds_read_b64_tr_b16 a[6:7], v29 offset:16896
    ds_read_b64_tr_b16 a[8:9], v30 offset:16384
    ds_read_b64_tr_b16 a[10:11], v30 offset:16896
    ds_read_b64_tr_b16 a[12:13], v31 offset:16384
    ds_read_b64_tr_b16 a[14:15], v31 offset:16896
    s_waitcnt vmcnt(20)
    ds_read_b64_tr_b16 a[16:17], v28 offset:20480
    ds_read_b64_tr_b16 a[18:19], v28 offset:20992
    ds_read_b64_tr_b16 a[20:21], v29 offset:20480
    ds_read_b64_tr_b16 a[22:23], v29 offset:20992
    ds_read_b64_tr_b16 a[24:25], v30 offset:20480
    ds_read_b64_tr_b16 a[26:27], v30 offset:20992
    ds_read_b64_tr_b16 a[28:29], v31 offset:20480
    ds_read_b64_tr_b16 a[30:31], v31 offset:20992
    s_waitcnt lgkmcnt(8)
    s_cmp_lt_u32 s59, 7
    s_cselect_b32 s3, s62, s63
    s_add_u32 m0, s64, 16384
    s_add_u32 s3, s3, 917504
    buffer_load_dwordx4 v240, s[24:27], s3 offen lds
    buffer_load_dwordx4 v241, s[24:27], s3 offen offset:1024 lds
    buffer_load_dwordx4 v242, s[24:27], s3 offen offset:2048 lds
    buffer_load_dwordx4 v243, s[24:27], s3 offen offset:3072 lds
    s_waitcnt vmcnt(20)
    ds_read_b64_tr_b16 a[32:33], v28 offset:0
    ds_read_b64_tr_b16 a[34:35], v28 offset:512
    ds_read_b64_tr_b16 a[36:37], v29 offset:0
    ds_read_b64_tr_b16 a[38:39], v29 offset:512
    ds_read_b64_tr_b16 a[40:41], v30 offset:0
    ds_read_b64_tr_b16 a[42:43], v30 offset:512
    ds_read_b64_tr_b16 a[44:45], v31 offset:0
    ds_read_b64_tr_b16 a[46:47], v31 offset:512
    s_waitcnt lgkmcnt(8)
    s_cmp_lt_u32 s59, 6
    s_cselect_b32 s3, s62, s63
    s_add_u32 m0, s64, 20480
    s_add_u32 s3, s3, 1048576
    buffer_load_dwordx4 v240, s[24:27], s3 offen lds
    buffer_load_dwordx4 v241, s[24:27], s3 offen offset:1024 lds
    buffer_load_dwordx4 v242, s[24:27], s3 offen offset:2048 lds
    buffer_load_dwordx4 v243, s[24:27], s3 offen offset:3072 lds
    s_waitcnt vmcnt(20)
    ds_read_b64_tr_b16 a[48:49], v28 offset:4096
    ds_read_b64_tr_b16 a[50:51], v28 offset:4608
    ds_read_b64_tr_b16 a[52:53], v29 offset:4096
    ds_read_b64_tr_b16 a[54:55], v29 offset:4608
    ds_read_b64_tr_b16 a[56:57], v30 offset:4096
    ds_read_b64_tr_b16 a[58:59], v30 offset:4608
    ds_read_b64_tr_b16 a[60:61], v31 offset:4096
    ds_read_b64_tr_b16 a[62:63], v31 offset:4608
    s_waitcnt lgkmcnt(8)
    s_cmp_lt_u32 s59, 5
    s_cselect_b32 s3, s62, s63
    s_add_u32 m0, s64, 0
    s_add_u32 s3, s3, 1179648
    buffer_load_dwordx4 v240, s[24:27], s3 offen lds
    buffer_load_dwordx4 v241, s[24:27], s3 offen offset:1024 lds
    buffer_load_dwordx4 v242, s[24:27], s3 offen offset:2048 lds
    buffer_load_dwordx4 v243, s[24:27], s3 offen offset:3072 lds
    s_waitcnt vmcnt(20)
    ds_read_b64_tr_b16 a[64:65], v28 offset:8192
    ds_read_b64_tr_b16 a[66:67], v28 offset:8704
    ds_read_b64_tr_b16 a[68:69], v29 offset:8192
    ds_read_b64_tr_b16 a[70:71], v29 offset:8704
    ds_read_b64_tr_b16 a[72:73], v30 offset:8192
    ds_read_b64_tr_b16 a[74:75], v30 offset:8704
    ds_read_b64_tr_b16 a[76:77], v31 offset:8192
    ds_read_b64_tr_b16 a[78:79], v31 offset:8704
    s_waitcnt lgkmcnt(8)
    s_cmp_lt_u32 s59, 4
    s_cselect_b32 s3, s62, s63
    s_add_u32 m0, s64, 4096
    s_add_u32 s3, s3, 1310720
    buffer_load_dwordx4 v240, s[24:27], s3 offen lds
    buffer_load_dwordx4 v241, s[24:27], s3 offen offset:1024 lds
    buffer_load_dwordx4 v242, s[24:27], s3 offen offset:2048 lds
    buffer_load_dwordx4 v243, s[24:27], s3 offen offset:3072 lds
    s_waitcnt vmcnt(20)
    ds_read_b64_tr_b16 a[80:81], v28 offset:12288
    ds_read_b64_tr_b16 a[82:83], v28 offset:12800
    ds_read_b64_tr_b16 a[84:85], v29 offset:12288
    ds_read_b64_tr_b16 a[86:87], v29 offset:12800
    ds_read_b64_tr_b16 a[88:89], v30 offset:12288
    ds_read_b64_tr_b16 a[90:91], v30 offset:12800
    ds_read_b64_tr_b16 a[92:93], v31 offset:12288
    ds_read_b64_tr_b16 a[94:95], v31 offset:12800
    s_waitcnt lgkmcnt(8)
    s_cmp_lt_u32 s59, 3
    s_cselect_b32 s3, s62, s63
    s_add_u32 m0, s64, 8192
    s_add_u32 s3, s3, 1441792
    buffer_load_dwordx4 v240, s[24:27], s3 offen lds
    buffer_load_dwordx4 v241, s[24:27], s3 offen offset:1024 lds
    buffer_load_dwordx4 v242, s[24:27], s3 offen offset:2048 lds
    buffer_load_dwordx4 v243, s[24:27], s3 offen offset:3072 lds
    s_waitcnt vmcnt(20)
    ds_read_b64_tr_b16 a[96:97], v244 offset:49152
    ds_read_b64_tr_b16 a[98:99], v244 offset:49664
    ds_read_b64_tr_b16 a[100:101], v245 offset:49152
    ds_read_b64_tr_b16 a[102:103], v245 offset:49664
    ds_read_b64_tr_b16 a[104:105], v246 offset:49152
    ds_read_b64_tr_b16 a[106:107], v246 offset:49664
    ds_read_b64_tr_b16 a[108:109], v247 offset:49152
    ds_read_b64_tr_b16 a[110:111], v247 offset:49664
    s_waitcnt lgkmcnt(8)
    s_cmp_lt_u32 s59, 2
    s_cselect_b32 s3, s62, s63
    s_add_u32 m0, s64, 12288
    s_add_u32 s3, s3, 1572864
    buffer_load_dwordx4 v240, s[24:27], s3 offen lds
    buffer_load_dwordx4 v241, s[24:27], s3 offen offset:1024 lds
    buffer_load_dwordx4 v242, s[24:27], s3 offen offset:2048 lds
    buffer_load_dwordx4 v243, s[24:27], s3 offen offset:3072 lds
    s_lshl_b32 s53, s55, 5
    s_add_u32 s53, s53, s57
    s_lshl2_add_u32 s53, s53, s44
    s_lshl_b32 s53, s53, 7
    s_add_u32 s53, s53, 0x880000
    s_mul_i32 s46, s44, 14
    s_add_u32 s46, s46, s59
    s_lshl_b32 s12, s46, 11
    s_mul_i32 s46, s55, 229376
    s_add_u32 s12, s12, s46
    s_add_u32 s12, s12, 0x600000
    s_sub_u32 s13, s12, 28672
    s_lshl2_add_u32 s16, s57, s44
    s_lshl_b32 s46, s16, 5
    v_lshlrev_b32 v4, 1, v3
    buffer_load_ushort v26, v4, s[28:31], s46 offen
    s_lshl_b32 s16, s16, 7
    s_add_u32 s16, s16, s55
    s_lshl_b32 s16, s16, 7
    v_lshrrev_b32 v19, 3, v3
    v_and_b32 v5, 1, v3
    v_lshl_add_u32 v19, v5, 1, v19
    v_bfe_u32 v5, v3, 1, 1
    v_lshlrev_b32 v5, 4, v5
    v_mov_b32 v24, 0x3f80
    v_lshlrev_b32 v5, v5, v24
    v_cmp_eq_u32 vcc, v19, v2
    s_nop 1
    v_cndmask_b32 v5, 0, v5, vcc
    v_and_b32 v19, 4, v3
    v_cmp_eq_u32 vcc, 0, v19
    s_nop 1
    v_cndmask_b32 v24, 0, v5, vcc
    v_cndmask_b32_e64 v25, v5, 0, vcc
    v_lshrrev_b32 v19, 1, v2
    v_lshlrev_b32 v13, 17, v19
    v_lshl_add_u32 v13, v3, 4, v13
    v_and_b32 v5, 1, v2
    v_lshl_add_u32 v13, v5, 3, v13
    v_lshlrev_b32 v14, 10, v3
    v_lshl_add_u32 v14, v5, 5, v14
    v_lshl_add_u32 v14, v19, 4, v14
    s_lshl_b32 s17, s55, 6
    s_add_u32 s17, s17, s57
    s_lshl4_add_u32 s17, s17, s44
    s_lshl_b32 s17, s17, 8
    s_add_u32 s17, s17, 0x400000
    s_load_dwordx8 s[4:11], s[40:41], s53 glc
L_p3s_c:
    s_waitcnt lgkmcnt(0)
    s_xor_b64 s[4:5], s[4:5], s[68:69]
    s_xor_b64 s[6:7], s[6:7], s[68:69]
    s_xor_b64 s[8:9], s[8:9], s[68:69]
    s_xor_b64 s[10:11], s[10:11], s[68:69]
    s_or_b64 s[4:5], s[4:5], s[6:7]
    s_or_b64 s[8:9], s[8:9], s[10:11]
    s_or_b64 s[4:5], s[4:5], s[8:9]
    s_cbranch_scc0 L_p3s_ok
    s_load_dwordx8 s[4:11], s[40:41], s53 glc
    s_sub_u32 s45, s45, 1
    s_cbranch_scc0 L_p3s_c
    s_mov_b32 s45, 0
    s_waitcnt lgkmcnt(0)
L_p3s_ok:
    s_waitcnt vmcnt(0) lgkmcnt(0)
    s_cmp_lt_u32 s59, 14
    s_cselect_b32 s49, s12, s13
    s_add_u32 s49, s49, 0
    buffer_load_dwordx4 v[160:163], v0, s[40:43], s49 offen offset:0 sc1
    buffer_load_dwordx4 v[164:167], v0, s[40:43], s49 offen offset:1024 sc1
    buffer_load_dwordx4 v[168:171], v0, s[40:43], s49 offen offset:2048 sc1
    buffer_load_dwordx4 v[172:175], v0, s[40:43], s49 offen offset:3072 sc1
    s_cmp_lt_u32 s59, 12
    s_cselect_b32 s49, s12, s13
    s_add_u32 s49, s49, 4096
    buffer_load_dwordx4 v[176:179], v0, s[40:43], s49 offen offset:0 sc1
    buffer_load_dwordx4 v[180:183], v0, s[40:43], s49 offen offset:1024 sc1
    buffer_load_dwordx4 v[184:187], v0, s[40:43], s49 offen offset:2048 sc1
    buffer_load_dwordx4 v[188:191], v0, s[40:43], s49 offen offset:3072 sc1
    s_cmp_lt_u32 s59, 10
    s_cselect_b32 s49, s12, s13
    s_add_u32 s49, s49, 8192
    buffer_load_dwordx4 v[192:195], v0, s[40:43], s49 offen offset:0 sc1
    buffer_load_dwordx4 v[196:199], v0, s[40:43], s49 offen offset:1024 sc1
    buffer_load_dwordx4 v[200:203], v0, s[40:43], s49 offen offset:2048 sc1
    buffer_load_dwordx4 v[204:207], v0, s[40:43], s49 offen offset:3072 sc1
    s_cmp_lt_u32 s59, 8
    s_cselect_b32 s49, s12, s13
    s_add_u32 s49, s49, 12288
    buffer_load_dwordx4 v[208:211], v0, s[40:43], s49 offen offset:0 sc1
    buffer_load_dwordx4 v[212:215], v0, s[40:43], s49 offen offset:1024 sc1
    buffer_load_dwordx4 v[216:219], v0, s[40:43], s49 offen offset:2048 sc1
    buffer_load_dwordx4 v[220:223], v0, s[40:43], s49 offen offset:3072 sc1
    s_waitcnt vmcnt(0) lgkmcnt(0)
    s_branch L_join3
L_non:
    s_load_dword s68, s[36:37], 0 glc
    s_waitcnt lgkmcnt(0)
    s_cmp_lg_u32 s68, 0
    s_cbranch_scc1 L_nonok
    s_sub_u32 s45, s45, 1
    s_cbranch_scc0 L_non
    s_mov_b32 s45, 0
    s_branch L_nonok
L_ro0:
    s_sub_u32 s45, s45, 1
    s_cbranch_scc1 L_ro0_x
    s_add_u32 s49, s51, 0
    buffer_load_dwordx4 v[64:67], v0, s[40:43], s49 offen offset:0 sc1
    buffer_load_dwordx4 v[68:71], v0, s[40:43], s49 offen offset:1024 sc1
    buffer_load_dwordx4 v[72:75], v0, s[40:43], s49 offen offset:2048 sc1
    buffer_load_dwordx4 v[76:79], v0, s[40:43], s49 offen offset:3072 sc1
    s_waitcnt vmcnt(0)
    v_max3_u32 v253, v64, v68, v72
    v_max_u32 v253, v253, v76
    v_cmp_eq_u32 vcc, -1, v253
    s_cbranch_vccnz L_ro0
    s_branch L_ro0_b
L_ro0_x:
    s_mov_b32 s45, 0
    s_branch L_ro0_b
L_ro1:
    s_sub_u32 s45, s45, 1
    s_cbranch_scc1 L_ro1_x
    s_add_u32 s49, s51, 4096
    buffer_load_dwordx4 v[80:83], v0, s[40:43], s49 offen offset:0 sc1
    buffer_load_dwordx4 v[84:87], v0, s[40:43], s49 offen offset:1024 sc1
    buffer_load_dwordx4 v[88:91], v0, s[40:43], s49 offen offset:2048 sc1
    buffer_load_dwordx4 v[92:95], v0, s[40:43], s49 offen offset:3072 sc1
    s_waitcnt vmcnt(0)
    v_max3_u32 v253, v80, v84, v88
    v_max_u32 v253, v253, v92
    v_cmp_eq_u32 vcc, -1, v253
    s_cbranch_vccnz L_ro1
    s_branch L_ro1_b
L_ro1_x:
    s_mov_b32 s45, 0
    s_branch L_ro1_b
L_ro2:
    s_sub_u32 s45, s45, 1
    s_cbranch_scc1 L_ro2_x
    s_add_u32 s49, s51, 8192
    buffer_load_dwordx4 v[96:99], v0, s[40:43], s49 offen offset:0 sc1
    buffer_load_dwordx4 v[100:103], v0, s[40:43], s49 offen offset:1024 sc1
    buffer_load_dwordx4 v[104:107], v0, s[40:43], s49 offen offset:2048 sc1
    buffer_load_dwordx4 v[108:111], v0, s[40:43], s49 offen offset:3072 sc1
    s_waitcnt vmcnt(0)
    v_max3_u32 v253, v96, v100, v104
    v_max_u32 v253, v253, v108
    v_cmp_eq_u32 vcc, -1, v253
    s_cbranch_vccnz L_ro2
    s_branch L_ro2_b
L_ro2_x:
    s_mov_b32 s45, 0
    s_branch L_ro2_b
L_ro3:
    s_sub_u32 s45, s45, 1
    s_cbranch_scc1 L_ro3_x
    s_add_u32 s49, s51, 12288
    buffer_load_dwordx4 v[112:115], v0, s[40:43], s49 offen offset:0 sc1
    buffer_load_dwordx4 v[116:119], v0, s[40:43], s49 offen offset:1024 sc1
    buffer_load_dwordx4 v[120:123], v0, s[40:43], s49 offen offset:2048 sc1
    buffer_load_dwordx4 v[124:127], v0, s[40:43], s49 offen offset:3072 sc1
    s_waitcnt vmcnt(0)
    v_max3_u32 v253, v112, v116, v120
    v_max_u32 v253, v253, v124
    v_cmp_eq_u32 vcc, -1, v253
    s_cbranch_vccnz L_ro3
    s_branch L_ro3_b
L_ro3_x:
    s_mov_b32 s45, 0
    s_branch L_ro3_b
L_sx_x:
    s_mov_b32 s45, 0
    s_branch L_sx_ok
L_uw:
    s_sub_u32 s45, s45, 1
    s_cbranch_scc1 L_uw_x
    s_load_dword s4, s[40:41], s5 offset:28 glc
    s_waitcnt lgkmcnt(0)
    s_cmp_eq_u32 s4, s68
    s_cbranch_scc0 L_uw
    s_branch L_uw_b
L_uw_x:
    s_mov_b32 s45, 0
    s_branch L_uw_b
L_ra1_0:
    s_sub_u32 s45, s45, 1
    s_cbranch_scc1 L_ra1_0_x
    s_cmp_lt_u32 s58, 16
    s_cselect_b32 s36, s50, s51
    s_add_u32 s36, s36, 0
    buffer_load_dwordx4 v[128:131], v17, s[40:43], s36 offen offset:0 sc1
    buffer_load_dwordx4 v[132:135], v18, s[40:43], s36 offen offset:0 sc1
    buffer_load_dwordx4 v[136:139], v17, s[40:43], s36 offen offset:2048 sc1
    buffer_load_dwordx4 v[140:143], v18, s[40:43], s36 offen offset:2048 sc1
    s_waitcnt vmcnt(0)
    v_max3_u32 v253, v128, v132, v136
    v_max_u32 v253, v253, v140
    v_cmp_eq_u32 vcc, -1, v253
    s_cbranch_vccnz L_ra1_0
    s_branch L_ra1_0_b
L_ra1_0_x:
    s_mov_b32 s45, 0
    s_branch L_ra1_0_b
L_ra1_1:
    s_sub_u32 s45, s45, 1
    s_cbranch_scc1 L_ra1_1_x
    s_cmp_lt_u32 s58, 14
    s_cselect_b32 s36, s50, s51
    s_add_u32 s36, s36, 4096
    buffer_load_dwordx4 v[144:147], v17, s[40:43], s36 offen offset:0 sc1
    buffer_load_dwordx4 v[148:151], v18, s[40:43], s36 offen offset:0 sc1
    buffer_load_dwordx4 v[152:155], v17, s[40:43], s36 offen offset:2048 sc1
    buffer_load_dwordx4 v[156:159], v18, s[40:43], s36 offen offset:2048 sc1
    s_waitcnt vmcnt(0)
    v_max3_u32 v253, v144, v148, v152
    v_max_u32 v253, v253, v156
    v_cmp_eq_u32 vcc, -1, v253
    s_cbranch_vccnz L_ra1_1
    s_branch L_ra1_1_b
L_ra1_1_x:
    s_mov_b32 s45, 0
    s_branch L_ra1_1_b
L_ra1_2:
    s_sub_u32 s45, s45, 1
    s_cbranch_scc1 L_ra1_2_x
    s_cmp_lt_u32 s58, 12
    s_cselect_b32 s36, s50, s51
    s_add_u32 s36, s36, 8192
    buffer_load_dwordx4 v[160:163], v17, s[40:43], s36 offen offset:0 sc1
    buffer_load_dwordx4 v[164:167], v18, s[40:43], s36 offen offset:0 sc1
    buffer_load_dwordx4 v[168:171], v17, s[40:43], s36 offen offset:2048 sc1
    buffer_load_dwordx4 v[172:175], v18, s[40:43], s36 offen offset:2048 sc1
    s_waitcnt vmcnt(0)
    v_max3_u32 v253, v160, v164, v168
    v_max_u32 v253, v253, v172
    v_cmp_eq_u32 vcc, -1, v253
    s_cbranch_vccnz L_ra1_2
    s_branch L_ra1_2_b
L_ra1_2_x:
    s_mov_b32 s45, 0
    s_branch L_ra1_2_b
L_ra1_3:
    s_sub_u32 s45, s45, 1
    s_cbranch_scc1 L_ra1_3_x
    s_cmp_lt_u32 s58, 10
    s_cselect_b32 s36, s50, s51
    s_add_u32 s36, s36, 12288
    buffer_load_dwordx4 v[176:179], v17, s[40:43], s36 offen offset:0 sc1
    buffer_load_dwordx4 v[180:183], v18, s[40:43], s36 offen offset:0 sc1
    buffer_load_dwordx4 v[184:187], v17, s[40:43], s36 offen offset:2048 sc1
    buffer_load_dwordx4 v[188:191], v18, s[40:43], s36 offen offset:2048 sc1
    s_waitcnt vmcnt(0)
    v_max3_u32 v253, v176, v180, v184
    v_max_u32 v253, v253, v188
    v_cmp_eq_u32 vcc, -1, v253
    s_cbranch_vccnz L_ra1_3
    s_branch L_ra1_3_b
L_ra1_3_x:
    s_mov_b32 s45, 0
    s_branch L_ra1_3_b
L_ra1_4:
    s_sub_u32 s45, s45, 1
    s_cbranch_scc1 L_ra1_4_x
    s_cmp_lt_u32 s58, 8
    s_cselect_b32 s36, s50, s51
    s_add_u32 s36, s36, 16384
    buffer_load_dwordx4 v[192:195], v17, s[40:43], s36 offen offset:0 sc1
    buffer_load_dwordx4 v[196:199], v18, s[40:43], s36 offen offset:0 sc1
    buffer_load_dwordx4 v[200:203], v17, s[40:43], s36 offen offset:2048 sc1
    buffer_load_dwordx4 v[204:207], v18, s[40:43], s36 offen offset:2048 sc1
    s_waitcnt vmcnt(0)
    v_max3_u32 v253, v192, v196, v200
    v_max_u32 v253, v253, v204
    v_cmp_eq_u32 vcc, -1, v253
    s_cbranch_vccnz L_ra1_4
    s_branch L_ra1_4_b
L_ra1_4_x:
    s_mov_b32 s45, 0
    s_branch L_ra1_4_b
L_ra1_5:
    s_sub_u32 s45, s45, 1
    s_cbranch_scc1 L_ra1_5_x
    s_cmp_lt_u32 s58, 6
    s_cselect_b32 s36, s50, s51
    s_add_u32 s36, s36, 20480
    buffer_load_dwordx4 v[208:211], v17, s[40:43], s36 offen offset:0 sc1
    buffer_load_dwordx4 v[212:215], v18, s[40:43], s36 offen offset:0 sc1
    buffer_load_dwordx4 v[216:219], v17, s[40:43], s36 offen offset:2048 sc1
    buffer_load_dwordx4 v[220:223], v18, s[40:43], s36 offen offset:2048 sc1
    s_waitcnt vmcnt(0)
    v_max3_u32 v253, v208, v212, v216
    v_max_u32 v253, v253, v220
    v_cmp_eq_u32 vcc, -1, v253
    s_cbranch_vccnz L_ra1_5
    s_branch L_ra1_5_b
L_ra1_5_x:
    s_mov_b32 s45, 0
    s_branch L_ra1_5_b
L_ra1_6:
    s_sub_u32 s45, s45, 1
    s_cbranch_scc1 L_ra1_6_x
    s_cmp_lt_u32 s58, 4
    s_cselect_b32 s36, s50, s51
    s_add_u32 s36, s36, 24576
    buffer_load_dwordx4 v[224:227], v17, s[40:43], s36 offen offset:0 sc1
    buffer_load_dwordx4 v[228:231], v18, s[40:43], s36 offen offset:0 sc1
    buffer_load_dwordx4 v[232:235], v17, s[40:43], s36 offen offset:2048 sc1
    buffer_load_dwordx4 v[236:239], v18, s[40:43], s36 offen offset:2048 sc1
    s_waitcnt vmcnt(0)
    v_max3_u32 v253, v224, v228, v232
    v_max_u32 v253, v253, v236
    v_cmp_eq_u32 vcc, -1, v253
    s_cbranch_vccnz L_ra1_6
    s_branch L_ra1_6_b
L_ra1_6_x:
    s_mov_b32 s45, 0
    s_branch L_ra1_6_b
L_ra1_7:
    s_sub_u32 s45, s45, 1
    s_cbranch_scc1 L_ra1_7_x
    s_cmp_lt_u32 s58, 2
    s_cselect_b32 s36, s50, s51
    s_add_u32 s36, s36, 28672
    buffer_load_dwordx4 v[128:131], v17, s[40:43], s36 offen offset:0 sc1
    buffer_load_dwordx4 v[132:135], v18, s[40:43], s36 offen offset:0 sc1
    buffer_load_dwordx4 v[136:139], v17, s[40:43], s36 offen offset:2048 sc1
    buffer_load_dwordx4 v[140:143], v18, s[40:43], s36 offen offset:2048 sc1
    s_waitcnt vmcnt(0)
    v_max3_u32 v253, v128, v132, v136
    v_max_u32 v253, v253, v140
    v_cmp_eq_u32 vcc, -1, v253
    s_cbranch_vccnz L_ra1_7
    s_branch L_ra1_7_b
L_ra1_7_x:
    s_mov_b32 s45, 0
    s_branch L_ra1_7_b
L_ra1_8:
    s_sub_u32 s45, s45, 1
    s_cbranch_scc1 L_ra1_8_x
    s_cmp_lt_u32 s58, 16
    s_cselect_b32 s36, s50, s51
    s_add_u32 s36, s36, 131072
    buffer_load_dwordx4 v[144:147], v17, s[40:43], s36 offen offset:0 sc1
    buffer_load_dwordx4 v[148:151], v18, s[40:43], s36 offen offset:0 sc1
    buffer_load_dwordx4 v[152:155], v17, s[40:43], s36 offen offset:2048 sc1
    buffer_load_dwordx4 v[156:159], v18, s[40:43], s36 offen offset:2048 sc1
    s_waitcnt vmcnt(0)
    v_max3_u32 v253, v144, v148, v152
    v_max_u32 v253, v253, v156
    v_cmp_eq_u32 vcc, -1, v253
    s_cbranch_vccnz L_ra1_8
    s_branch L_ra1_8_b
L_ra1_8_x:
    s_mov_b32 s45, 0
    s_branch L_ra1_8_b
L_ra1_9:
    s_sub_u32 s45, s45, 1
    s_cbranch_scc1 L_ra1_9_x
    s_cmp_lt_u32 s58, 14
    s_cselect_b32 s36, s50, s51
    s_add_u32 s36, s36, 135168
    buffer_load_dwordx4 v[160:163], v17, s[40:43], s36 offen offset:0 sc1
    buffer_load_dwordx4 v[164:167], v18, s[40:43], s36 offen offset:0 sc1
    buffer_load_dwordx4 v[168:171], v17, s[40:43], s36 offen offset:2048 sc1
    buffer_load_dwordx4 v[172:175], v18, s[40:43], s36 offen offset:2048 sc1
    s_waitcnt vmcnt(0)
    v_max3_u32 v253, v160, v164, v168
    v_max_u32 v253, v253, v172
    v_cmp_eq_u32 vcc, -1, v253
    s_cbranch_vccnz L_ra1_9
    s_branch L_ra1_9_b
L_ra1_9_x:
    s_mov_b32 s45, 0
    s_branch L_ra1_9_b
L_ra1_10:
    s_sub_u32 s45, s45, 1
    s_cbranch_scc1 L_ra1_10_x
    s_cmp_lt_u32 s58, 12
    s_cselect_b32 s36, s50, s51
    s_add_u32 s36, s36, 139264
    buffer_load_dwordx4 v[176:179], v17, s[40:43], s36 offen offset:0 sc1
    buffer_load_dwordx4 v[180:183], v18, s[40:43], s36 offen offset:0 sc1
    buffer_load_dwordx4 v[184:187], v17, s[40:43], s36 offen offset:2048 sc1
    buffer_load_dwordx4 v[188:191], v18, s[40:43], s36 offen offset:2048 sc1
    s_waitcnt vmcnt(0)
    v_max3_u32 v253, v176, v180, v184
    v_max_u32 v253, v253, v188
    v_cmp_eq_u32 vcc, -1, v253
    s_cbranch_vccnz L_ra1_10
    s_branch L_ra1_10_b
L_ra1_10_x:
    s_mov_b32 s45, 0
    s_branch L_ra1_10_b
L_ra1_11:
    s_sub_u32 s45, s45, 1
    s_cbranch_scc1 L_ra1_11_x
    s_cmp_lt_u32 s58, 10
    s_cselect_b32 s36, s50, s51
    s_add_u32 s36, s36, 143360
    buffer_load_dwordx4 v[192:195], v17, s[40:43], s36 offen offset:0 sc1
    buffer_load_dwordx4 v[196:199], v18, s[40:43], s36 offen offset:0 sc1
    buffer_load_dwordx4 v[200:203], v17, s[40:43], s36 offen offset:2048 sc1
    buffer_load_dwordx4 v[204:207], v18, s[40:43], s36 offen offset:2048 sc1
    s_waitcnt vmcnt(0)
    v_max3_u32 v253, v192, v196, v200
    v_max_u32 v253, v253, v204
    v_cmp_eq_u32 vcc, -1, v253
    s_cbranch_vccnz L_ra1_11
    s_branch L_ra1_11_b
L_ra1_11_x:
    s_mov_b32 s45, 0
    s_branch L_ra1_11_b
L_ra1_12:
    s_sub_u32 s45, s45, 1
    s_cbranch_scc1 L_ra1_12_x
    s_cmp_lt_u32 s58, 8
    s_cselect_b32 s36, s50, s51
    s_add_u32 s36, s36, 147456
    buffer_load_dwordx4 v[208:211], v17, s[40:43], s36 offen offset:0 sc1
    buffer_load_dwordx4 v[212:215], v18, s[40:43], s36 offen offset:0 sc1
    buffer_load_dwordx4 v[216:219], v17, s[40:43], s36 offen offset:2048 sc1
    buffer_load_dwordx4 v[220:223], v18, s[40:43], s36 offen offset:2048 sc1
    s_waitcnt vmcnt(0)
    v_max3_u32 v253, v208, v212, v216
    v_max_u32 v253, v253, v220
    v_cmp_eq_u32 vcc, -1, v253
    s_cbranch_vccnz L_ra1_12
    s_branch L_ra1_12_b
L_ra1_12_x:
    s_mov_b32 s45, 0
    s_branch L_ra1_12_b
L_ra1_13:
    s_sub_u32 s45, s45, 1
    s_cbranch_scc1 L_ra1_13_x
    s_cmp_lt_u32 s58, 6
    s_cselect_b32 s36, s50, s51
    s_add_u32 s36, s36, 151552
    buffer_load_dwordx4 v[224:227], v17, s[40:43], s36 offen offset:0 sc1
    buffer_load_dwordx4 v[228:231], v18, s[40:43], s36 offen offset:0 sc1
    buffer_load_dwordx4 v[232:235], v17, s[40:43], s36 offen offset:2048 sc1
    buffer_load_dwordx4 v[236:239], v18, s[40:43], s36 offen offset:2048 sc1
    s_waitcnt vmcnt(0)
    v_max3_u32 v253, v224, v228, v232
    v_max_u32 v253, v253, v236
    v_cmp_eq_u32 vcc, -1, v253
    s_cbranch_vccnz L_ra1_13
    s_branch L_ra1_13_b
L_ra1_13_x:
    s_mov_b32 s45, 0
    s_branch L_ra1_13_b
L_ra1_14:
    s_sub_u32 s45, s45, 1
    s_cbranch_scc1 L_ra1_14_x
    s_cmp_lt_u32 s58, 4
    s_cselect_b32 s36, s50, s51
    s_add_u32 s36, s36, 155648
    buffer_load_dwordx4 v[128:131], v17, s[40:43], s36 offen offset:0 sc1
    buffer_load_dwordx4 v[132:135], v18, s[40:43], s36 offen offset:0 sc1
    buffer_load_dwordx4 v[136:139], v17, s[40:43], s36 offen offset:2048 sc1
    buffer_load_dwordx4 v[140:143], v18, s[40:43], s36 offen offset:2048 sc1
    s_waitcnt vmcnt(0)
    v_max3_u32 v253, v128, v132, v136
    v_max_u32 v253, v253, v140
    v_cmp_eq_u32 vcc, -1, v253
    s_cbranch_vccnz L_ra1_14
    s_branch L_ra1_14_b
L_ra1_14_x:
    s_mov_b32 s45, 0
    s_branch L_ra1_14_b
L_ra1_15:
    s_sub_u32 s45, s45, 1
    s_cbranch_scc1 L_ra1_15_x
    s_cmp_lt_u32 s58, 2
    s_cselect_b32 s36, s50, s51
    s_add_u32 s36, s36, 159744
    buffer_load_dwordx4 v[144:147], v17, s[40:43], s36 offen offset:0 sc1
    buffer_load_dwordx4 v[148:151], v18, s[40:43], s36 offen offset:0 sc1
    buffer_load_dwordx4 v[152:155], v17, s[40:43], s36 offen offset:2048 sc1
    buffer_load_dwordx4 v[156:159], v18, s[40:43], s36 offen offset:2048 sc1
    s_waitcnt vmcnt(0)
    v_max3_u32 v253, v144, v148, v152
    v_max_u32 v253, v253, v156
    v_cmp_eq_u32 vcc, -1, v253
    s_cbranch_vccnz L_ra1_15
    s_branch L_ra1_15_b
L_ra1_15_x:
    s_mov_b32 s45, 0
    s_branch L_ra1_15_b
L_ra0_16:
    s_sub_u32 s45, s45, 1
    s_cbranch_scc1 L_ra0_16_x
    s_cmp_lt_u32 s59, 14
    s_cselect_b32 s36, s12, s13
    s_add_u32 s36, s36, 0
    buffer_load_dwordx4 v[160:163], v0, s[40:43], s36 offen offset:0 sc1
    buffer_load_dwordx4 v[164:167], v0, s[40:43], s36 offen offset:1024 sc1
    buffer_load_dwordx4 v[168:171], v0, s[40:43], s36 offen offset:2048 sc1
    buffer_load_dwordx4 v[172:175], v0, s[40:43], s36 offen offset:3072 sc1
    s_waitcnt vmcnt(0)
    v_max3_u32 v253, v160, v164, v168
    v_max_u32 v253, v253, v172
    v_cmp_eq_u32 vcc, -1, v253
    s_cbranch_vccnz L_ra0_16
    s_branch L_ra0_16_b
L_ra0_16_x:
    s_mov_b32 s45, 0
    s_branch L_ra0_16_b
L_ra0_17:
    s_sub_u32 s45, s45, 1
    s_cbranch_scc1 L_ra0_17_x
    s_cmp_lt_u32 s59, 12
    s_cselect_b32 s36, s12, s13
    s_add_u32 s36, s36, 4096
    buffer_load_dwordx4 v[176:179], v0, s[40:43], s36 offen offset:0 sc1
    buffer_load_dwordx4 v[180:183], v0, s[40:43], s36 offen offset:1024 sc1
    buffer_load_dwordx4 v[184:187], v0, s[40:43], s36 offen offset:2048 sc1
    buffer_load_dwordx4 v[188:191], v0, s[40:43], s36 offen offset:3072 sc1
    s_waitcnt vmcnt(0)
    v_max3_u32 v253, v176, v180, v184
    v_max_u32 v253, v253, v188
    v_cmp_eq_u32 vcc, -1, v253
    s_cbranch_vccnz L_ra0_17
    s_branch L_ra0_17_b
L_ra0_17_x:
    s_mov_b32 s45, 0
    s_branch L_ra0_17_b
L_ra0_18:
    s_sub_u32 s45, s45, 1
    s_cbranch_scc1 L_ra0_18_x
    s_cmp_lt_u32 s59, 10
    s_cselect_b32 s36, s12, s13
    s_add_u32 s36, s36, 8192
    buffer_load_dwordx4 v[192:195], v0, s[40:43], s36 offen offset:0 sc1
    buffer_load_dwordx4 v[196:199], v0, s[40:43], s36 offen offset:1024 sc1
    buffer_load_dwordx4 v[200:203], v0, s[40:43], s36 offen offset:2048 sc1
    buffer_load_dwordx4 v[204:207], v0, s[40:43], s36 offen offset:3072 sc1
    s_waitcnt vmcnt(0)
    v_max3_u32 v253, v192, v196, v200
    v_max_u32 v253, v253, v204
    v_cmp_eq_u32 vcc, -1, v253
    s_cbranch_vccnz L_ra0_18
    s_branch L_ra0_18_b
L_ra0_18_x:
    s_mov_b32 s45, 0
    s_branch L_ra0_18_b
L_ra0_19:
    s_sub_u32 s45, s45, 1
    s_cbranch_scc1 L_ra0_19_x
    s_cmp_lt_u32 s59, 8
    s_cselect_b32 s36, s12, s13
    s_add_u32 s36, s36, 12288
    buffer_load_dwordx4 v[208:211], v0, s[40:43], s36 offen offset:0 sc1
    buffer_load_dwordx4 v[212:215], v0, s[40:43], s36 offen offset:1024 sc1
    buffer_load_dwordx4 v[216:219], v0, s[40:43], s36 offen offset:2048 sc1
    buffer_load_dwordx4 v[220:223], v0, s[40:43], s36 offen offset:3072 sc1
    s_waitcnt vmcnt(0)
    v_max3_u32 v253, v208, v212, v216
    v_max_u32 v253, v253, v220
    v_cmp_eq_u32 vcc, -1, v253
    s_cbranch_vccnz L_ra0_19
    s_branch L_ra0_19_b
L_ra0_19_x:
    s_mov_b32 s45, 0
    s_branch L_ra0_19_b
L_ra0_20:
    s_sub_u32 s45, s45, 1
    s_cbranch_scc1 L_ra0_20_x
    s_cmp_lt_u32 s59, 6
    s_cselect_b32 s36, s12, s13
    s_add_u32 s36, s36, 16384
    buffer_load_dwordx4 v[224:227], v0, s[40:43], s36 offen offset:0 sc1
    buffer_load_dwordx4 v[228:231], v0, s[40:43], s36 offen offset:1024 sc1
    buffer_load_dwordx4 v[232:235], v0, s[40:43], s36 offen offset:2048 sc1
    buffer_load_dwordx4 v[236:239], v0, s[40:43], s36 offen offset:3072 sc1
    s_waitcnt vmcnt(0)
    v_max3_u32 v253, v224, v228, v232
    v_max_u32 v253, v253, v236
    v_cmp_eq_u32 vcc, -1, v253
    s_cbranch_vccnz L_ra0_20
    s_branch L_ra0_20_b
L_ra0_20_x:
    s_mov_b32 s45, 0
    s_branch L_ra0_20_b
L_ra0_21:
    s_sub_u32 s45, s45, 1
    s_cbranch_scc1 L_ra0_21_x
    s_cmp_lt_u32 s59, 4
    s_cselect_b32 s36, s12, s13
    s_add_u32 s36, s36, 20480
    buffer_load_dwordx4 v[128:131], v0, s[40:43], s36 offen offset:0 sc1
    buffer_load_dwordx4 v[132:135], v0, s[40:43], s36 offen offset:1024 sc1
    buffer_load_dwordx4 v[136:139], v0, s[40:43], s36 offen offset:2048 sc1
    buffer_load_dwordx4 v[140:143], v0, s[40:43], s36 offen offset:3072 sc1
    s_waitcnt vmcnt(0)
    v_max3_u32 v253, v128, v132, v136
    v_max_u32 v253, v253, v140
    v_cmp_eq_u32 vcc, -1, v253
    s_cbranch_vccnz L_ra0_21
    s_branch L_ra0_21_b
L_ra0_21_x:
    s_mov_b32 s45, 0
    s_branch L_ra0_21_b
L_ra0_22:
    s_sub_u32 s45, s45, 1
    s_cbranch_scc1 L_ra0_22_x
    s_cmp_lt_u32 s59, 2
    s_cselect_b32 s36, s12, s13
    s_add_u32 s36, s36, 24576
    buffer_load_dwordx4 v[144:147], v0, s[40:43], s36 offen offset:0 sc1
    buffer_load_dwordx4 v[148:151], v0, s[40:43], s36 offen offset:1024 sc1
    buffer_load_dwordx4 v[152:155], v0, s[40:43], s36 offen offset:2048 sc1
    buffer_load_dwordx4 v[156:159], v0, s[40:43], s36 offen offset:3072 sc1
    s_waitcnt vmcnt(0)
    v_max3_u32 v253, v144, v148, v152
    v_max_u32 v253, v253, v156
    v_cmp_eq_u32 vcc, -1, v253
    s_cbranch_vccnz L_ra0_22
    s_branch L_ra0_22_b
L_ra0_22_x:
    s_mov_b32 s45, 0
    s_branch L_ra0_22_b
L_ra0_23:
    s_sub_u32 s45, s45, 1
    s_cbranch_scc1 L_ra0_23_x
    s_cmp_lt_u32 s59, 14
    s_cselect_b32 s36, s12, s13
    s_add_u32 s36, s36, 114688
    buffer_load_dwordx4 v[160:163], v0, s[40:43], s36 offen offset:0 sc1
    buffer_load_dwordx4 v[164:167], v0, s[40:43], s36 offen offset:1024 sc1
    buffer_load_dwordx4 v[168:171], v0, s[40:43], s36 offen offset:2048 sc1
    buffer_load_dwordx4 v[172:175], v0, s[40:43], s36 offen offset:3072 sc1
    s_waitcnt vmcnt(0)
    v_max3_u32 v253, v160, v164, v168
    v_max_u32 v253, v253, v172
    v_cmp_eq_u32 vcc, -1, v253
    s_cbranch_vccnz L_ra0_23
    s_branch L_ra0_23_b
L_ra0_23_x:
    s_mov_b32 s45, 0
    s_branch L_ra0_23_b
L_ra0_24:
    s_sub_u32 s45, s45, 1
    s_cbranch_scc1 L_ra0_24_x
    s_cmp_lt_u32 s59, 12
    s_cselect_b32 s36, s12, s13
    s_add_u32 s36, s36, 118784
    buffer_load_dwordx4 v[176:179], v0, s[40:43], s36 offen offset:0 sc1
    buffer_load_dwordx4 v[180:183], v0, s[40:43], s36 offen offset:1024 sc1
    buffer_load_dwordx4 v[184:187], v0, s[40:43], s36 offen offset:2048 sc1
    buffer_load_dwordx4 v[188:191], v0, s[40:43], s36 offen offset:3072 sc1
    s_waitcnt vmcnt(0)
    v_max3_u32 v253, v176, v180, v184
    v_max_u32 v253, v253, v188
    v_cmp_eq_u32 vcc, -1, v253
    s_cbranch_vccnz L_ra0_24
    s_branch L_ra0_24_b
L_ra0_24_x:
    s_mov_b32 s45, 0
    s_branch L_ra0_24_b
L_ra0_25:
    s_sub_u32 s45, s45, 1
    s_cbranch_scc1 L_ra0_25_x
    s_cmp_lt_u32 s59, 10
    s_cselect_b32 s36, s12, s13
    s_add_u32 s36, s36, 122880
    buffer_load_dwordx4 v[192:195], v0, s[40:43], s36 offen offset:0 sc1
    buffer_load_dwordx4 v[196:199], v0, s[40:43], s36 offen offset:1024 sc1
    buffer_load_dwordx4 v[200:203], v0, s[40:43], s36 offen offset:2048 sc1
    buffer_load_dwordx4 v[204:207], v0, s[40:43], s36 offen offset:3072 sc1
    s_waitcnt vmcnt(0)
    v_max3_u32 v253, v192, v196, v200
    v_max_u32 v253, v253, v204
    v_cmp_eq_u32 vcc, -1, v253
    s_cbranch_vccnz L_ra0_25
    s_branch L_ra0_25_b
L_ra0_25_x:
    s_mov_b32 s45, 0
    s_branch L_ra0_25_b
L_ra0_26:
    s_sub_u32 s45, s45, 1
    s_cbranch_scc1 L_ra0_26_x
    s_cmp_lt_u32 s59, 8
    s_cselect_b32 s36, s12, s13
    s_add_u32 s36, s36, 126976
    buffer_load_dwordx4 v[208:211], v0, s[40:43], s36 offen offset:0 sc1
    buffer_load_dwordx4 v[212:215], v0, s[40:43], s36 offen offset:1024 sc1
    buffer_load_dwordx4 v[216:219], v0, s[40:43], s36 offen offset:2048 sc1
    buffer_load_dwordx4 v[220:223], v0, s[40:43], s36 offen offset:3072 sc1
    s_waitcnt vmcnt(0)
    v_max3_u32 v253, v208, v212, v216
    v_max_u32 v253, v253, v220
    v_cmp_eq_u32 vcc, -1, v253
    s_cbranch_vccnz L_ra0_26
    s_branch L_ra0_26_b
L_ra0_26_x:
    s_mov_b32 s45, 0
    s_branch L_ra0_26_b
L_ra0_27:
    s_sub_u32 s45, s45, 1
    s_cbranch_scc1 L_ra0_27_x
    s_cmp_lt_u32 s59, 6
    s_cselect_b32 s36, s12, s13
    s_add_u32 s36, s36, 131072
    buffer_load_dwordx4 v[224:227], v0, s[40:43], s36 offen offset:0 sc1
    buffer_load_dwordx4 v[228:231], v0, s[40:43], s36 offen offset:1024 sc1
    buffer_load_dwordx4 v[232:235], v0, s[40:43], s36 offen offset:2048 sc1
    buffer_load_dwordx4 v[236:239], v0, s[40:43], s36 offen offset:3072 sc1
    s_waitcnt vmcnt(0)
    v_max3_u32 v253, v224, v228, v232
    v_max_u32 v253, v253, v236
    v_cmp_eq_u32 vcc, -1, v253
    s_cbranch_vccnz L_ra0_27
    s_branch L_ra0_27_b
L_ra0_27_x:
    s_mov_b32 s45, 0
    s_branch L_ra0_27_b
L_ra0_28:
    s_sub_u32 s45, s45, 1
    s_cbranch_scc1 L_ra0_28_x
    s_cmp_lt_u32 s59, 4
    s_cselect_b32 s36, s12, s13
    s_add_u32 s36, s36, 135168
    buffer_load_dwordx4 v[128:131], v0, s[40:43], s36 offen offset:0 sc1
    buffer_load_dwordx4 v[132:135], v0, s[40:43], s36 offen offset:1024 sc1
    buffer_load_dwordx4 v[136:139], v0, s[40:43], s36 offen offset:2048 sc1
    buffer_load_dwordx4 v[140:143], v0, s[40:43], s36 offen offset:3072 sc1
    s_waitcnt vmcnt(0)
    v_max3_u32 v253, v128, v132, v136
    v_max_u32 v253, v253, v140
    v_cmp_eq_u32 vcc, -1, v253
    s_cbranch_vccnz L_ra0_28
    s_branch L_ra0_28_b
L_ra0_28_x:
    s_mov_b32 s45, 0
    s_branch L_ra0_28_b
L_ra0_29:
    s_sub_u32 s45, s45, 1
    s_cbranch_scc1 L_ra0_29_x
    s_cmp_lt_u32 s59, 2
    s_cselect_b32 s36, s12, s13
    s_add_u32 s36, s36, 139264
    buffer_load_dwordx4 v[144:147], v0, s[40:43], s36 offen offset:0 sc1
    buffer_load_dwordx4 v[148:151], v0, s[40:43], s36 offen offset:1024 sc1
    buffer_load_dwordx4 v[152:155], v0, s[40:43], s36 offen offset:2048 sc1
    buffer_load_dwordx4 v[156:159], v0, s[40:43], s36 offen offset:3072 sc1
    s_waitcnt vmcnt(0)
    v_max3_u32 v253, v144, v148, v152
    v_max_u32 v253, v253, v156
    v_cmp_eq_u32 vcc, -1, v253
    s_cbranch_vccnz L_ra0_29
    s_branch L_ra0_29_b
L_ra0_29_x:
    s_mov_b32 s45, 0
    s_branch L_ra0_29_b
.p2align 8, 0
L_last:
.fill 64, 4, 0xbf810000
.section .rodata,"a"
.p2align 6
.amdhsa_kernel sequential_preLN__sliding_local_dilated__mixer_token_mlp__prompt_kernel
  .amdhsa_next_free_vgpr 512
  .amdhsa_next_free_sgpr 102
  .amdhsa_accum_offset 256
  .amdhsa_group_segment_fixed_size 0
  .amdhsa_kernarg_size 88
  .amdhsa_user_sgpr_count 2
  .amdhsa_user_sgpr_kernarg_segment_ptr 1
  .amdhsa_system_sgpr_workgroup_id_x 1
.end_amdhsa_kernel
```
